```python
import torch

def _softmax(x, axis=-1):
    return torch.softmax(x, dim=axis)

def _gelu(x):
    return torch.nn.functional.gelu(x, approximate='tanh')

def _silu(x):
    return torch.nn.functional.silu(x)

def _sigmoid(x):
    return torch.sigmoid(x)

def _layernorm(x, axis=-1, eps=1e-05):
    m = x.mean(dim=axis, keepdim=True)
    v = x.var(dim=axis, keepdim=True, unbiased=False)
    return (x - m) / torch.sqrt(v + eps)

def _scatter_add(tgt, idx, src, axis=0):
    return tgt.clone().index_add_(axis, idx, src)

def _segment_sum(src, seg, n):
    out = torch.zeros((n,) + src.shape[1:], dtype=src.dtype)
    return out.index_add_(0, seg, src)

def _pad(x, pw):
    flat = tuple((v for pair in reversed(pw) for v in pair))
    return torch.nn.functional.pad(x, flat)
kernel_name = 'adaLN_cond__compressed_kv_cla__mixer_channel_mlp__decode'

def setup_inputs():

    _w = lambda a: (lambda t: t.to(torch.bfloat16) if t.is_floating_point() else t)(torch.as_tensor(a))

    def _A_setup():
        B, H, Sq, Sk, D, M = (1, 32, 1, 4096, 128, 512)
        Dc = 4 * D
        return {'x': _w((lambda *s: torch.randn(*s, dtype=torch.bfloat16) * 0.1)(B, Sq, M)), 'c_kv': _w((lambda *s: torch.randn(*s, dtype=torch.bfloat16) * 0.8)(B, Sk, Dc)), 'w_q': _w((lambda *s: torch.randn(*s, dtype=torch.bfloat16) * 0.8)(M, H, D) * M ** (-0.5)), 'w_uk': _w((lambda *s: torch.randn(*s, dtype=torch.bfloat16) * 0.8)(Dc, H, D) * Dc ** (-0.5)), 'w_uv': _w((lambda *s: torch.randn(*s, dtype=torch.bfloat16) * 0.8)(Dc, H, D) * Dc ** (-0.5)), 'w_o': _w((lambda *s: torch.randn(*s, dtype=torch.bfloat16) * 0.8)(H, D, M) * (H * D) ** (-0.5))}
    _A_in = _A_setup()

    def _B_setup():
        B, S, D, F = (1, 1, 512, 1376)
        return {'x': _w((lambda *s: torch.randn(*s, dtype=torch.bfloat16) * 0.1)(B, S, D)), 'w1': _w((lambda *s: torch.randn(*s, dtype=torch.bfloat16) * 3.2)(D, F) * D ** (-0.5)), 'b1': _w((lambda *s: torch.randn(*s, dtype=torch.bfloat16) * 3.2)(F)), 'w2': _w((lambda *s: torch.randn(*s, dtype=torch.bfloat16) * 3.2)(F, D) * F ** (-0.5)), 'b2': _w((lambda *s: torch.randn(*s, dtype=torch.bfloat16) * 3.2)(D))}
    _B_in = _B_setup()
    return {'A_x': _A_in['x'], 'A_c_kv': _A_in['c_kv'], 'A_w_q': _A_in['w_q'], 'A_w_uk': _A_in['w_uk'], 'A_w_uv': _A_in['w_uv'], 'A_w_o': _A_in['w_o'], 'B_x': _B_in['x'], 'B_w1': _B_in['w1'], 'B_b1': _B_in['b1'], 'B_w2': _B_in['w2'], 'B_b2': _B_in['b2'], 'c': _w((lambda *s: torch.randn(*s, dtype=torch.bfloat16) * 0.4)(1, 512) * 8.0), 'w_mod': _w((lambda *s: torch.randn(*s, dtype=torch.bfloat16) * 0.4)(512, 6 * 512) * 512 ** (-0.5) * 8.0)}

def reference(A_x, A_c_kv, A_w_q, A_w_uk, A_w_uv, A_w_o, B_x, B_w1, B_b1, B_w2, B_b2, c, w_mod):

    def _A_ref(x, c_kv, w_q, w_uk, w_uv, w_o):
        B, Sq, M = (x.shape[0], x.shape[1], x.shape[2])
        Sk = c_kv.shape[1]
        H, D = (w_q.shape[1], w_q.shape[2])
        q = torch.einsum('bqm,mhd->bhqd', x, w_q)
        k = torch.einsum('bkc,chd->bhkd', c_kv, w_uk)
        v = torch.einsum('bkc,chd->bhkd', c_kv, w_uv)
        scores = torch.einsum('bhqd,bhkd->bhqk', q, k) * D ** (-0.5)
        off = Sk - Sq
        qi = torch.arange(Sq)[:, None]
        kj = torch.arange(Sk)[None, :]
        cmask = kj <= qi + off
        scores = torch.where(cmask[None, None], scores, -1000000000.0)
        p = _softmax(scores, axis=-1)
        ctx = torch.einsum('bhqk,bhkd->bhqd', p, v)
        return torch.einsum('bhqd,hdm->bqm', ctx, w_o)

    def _B_ref(x, w1, b1, w2, b2):
        y = _layernorm(x, axis=-1)
        h = _gelu(torch.einsum('bsd,df->bsf', y, w1) + b1)
        return torch.einsum('bsf,fd->bsd', h, w2) + b2
    x = A_x
    mod = (_silu(c) @ w_mod).reshape(c.shape[0], 6, 1, -1)
    sa, ca, ga, sb, cb, gb = (mod[:, 0].clone(), mod[:, 1].clone(), mod[:, 2].clone(), mod[:, 3].clone(), mod[:, 4].clone(), mod[:, 5].clone())
    h = _layernorm(x, axis=-1) * (1 + ca) + sa
    x = x + ga * _A_ref(h, A_c_kv, A_w_q, A_w_uk, A_w_uv, A_w_o)
    h = _layernorm(x, axis=-1) * (1 + cb) + sb
    x = x + gb * _B_ref(h, B_w1, B_b1, B_w2, B_b2)
    return x
```

```asm
; @launch grid=(256,1,1) block=(512,1,1) lds=155136
.amdgcn_target "amdgcn-amd-amdhsa--gfx950"
.text
.globl adaLN_cond__compressed_kv_cla__mixer_channel_mlp__decode_kernel
.p2align 8
.type adaLN_cond__compressed_kv_cla__mixer_channel_mlp__decode_kernel,@function
adaLN_cond__compressed_kv_cla__mixer_channel_mlp__decode_kernel:
    s_cmp_ge_u32 s2, 256
    s_cbranch_scc1 L_end
    s_load_dwordx16 s[16:31], s[0:1], 0
    s_load_dwordx16 s[32:47], s[0:1], 64
    v_and_b32 v1, 63, v0
    v_lshrrev_b32 v2, 6, v0
    s_and_b32 s4, s2, 7
    v_readfirstlane_b32 s3, v2
    s_lshr_b32 s5, s2, 3
    s_and_b32 s6, s5, 3
    s_lshr_b32 s7, s5, 2
    s_mov_b32 s9, 0
    s_mov_b32 s8, 0
    s_mov_b32 s93, 0
    s_mov_b64 s[96:97], -1
    s_lshr_b32 s48, s7, 1
    s_lshl_b32 s10, s4, 2
    s_add_u32 s48, s48, s10
    s_and_b32 s49, s7, 1
    v_mov_b32 v252, 0x600000
    s_waitcnt lgkmcnt(0)
    global_load_dword v253, v252, s[46:47] sc1
    s_cmp_eq_u32 s6, 1
    s_cbranch_scc1 L_roleB
    s_cmp_eq_u32 s6, 2
    s_cbranch_scc1 L_roleC
    s_cmp_eq_u32 s6, 3
    s_cbranch_scc1 L_roleA
L_roleD:
    s_lshl_b32 s50, s7, 3
    s_add_u32 s50, s50, s4
    v_lshlrev_b32 v3, 1, v0
    global_load_ushort v8, v3, s[38:39]
    s_lshr_b32 s51, s50, 4
    s_and_b32 s52, s50, 15
    v_lshrrev_b32 v10, 3, v1
    v_lshlrev_b32 v10, 1, v10
    s_lshl_b32 s10, s3, 4
    s_lshl_b32 s11, s51, 7
    s_add_u32 s10, s10, s11
    v_add_u32 v10, s10, v10
    v_lshlrev_b32 v49, 2, v10
    s_movk_i32 s10, 6144
    v_mul_lo_u32 v10, v10, s10
    v_and_b32 v3, 7, v1
    v_lshl_add_u32 v10, v3, 4, v10
    s_lshl_b32 s10, s52, 7
    v_add_u32 v10, s10, v10
    global_load_dwordx4 v[56:59], v10, s[40:41] nt
    s_add_u32 s12, s40, 6144
    s_addc_u32 s13, s41, 0
    global_load_dwordx4 v[60:63], v10, s[12:13] nt
    v_lshrrev_b32 v2, 3, v1
    v_lshlrev_b32 v2, 5, v2
    s_lshl_b32 s10, s3, 8
    v_add_u32 v2, s10, v2
    v_and_b32 v48, 7, v1
    v_lshlrev_b32 v48, 5, v48
    v_and_b32 v3, 16, v1
    v_add3_u32 v48, v48, v3, s10
    v_and_b32 v3, 1, v1
    v_lshlrev_b32 v3, 4, v3
    v_mov_b32 v55, 0xffff
    v_lshlrev_b32 v55, v3, v55
    v_bfe_u32 v3, v1, 1, 2
    v_cmp_eq_u32 vcc, 0, v3
    s_nop 1
    v_cndmask_b32 v52, 0, v55, vcc
    v_cmp_eq_u32 vcc, 1, v3
    s_nop 1
    v_cndmask_b32 v53, 0, v55, vcc
    v_cmp_eq_u32 vcc, 2, v3
    s_nop 1
    v_cndmask_b32 v54, 0, v55, vcc
    v_cmp_eq_u32 vcc, 3, v3
    s_nop 1
    v_cndmask_b32 v55, 0, v55, vcc
    s_waitcnt vmcnt(2)
    v_readfirstlane_b32 s8, v253
    s_nop 3
    s_add_u32 s8, s8, 1
    s_xor_b32 s93, s8, 0x5bd1e995
    v_lshlrev_b32 v9, 16, v8
    v_mul_f32 v3, 0xbfb8aa3b, v9
    v_exp_f32 v3, v3
    s_nop 0
    v_add_f32 v3, 1.0, v3
    v_rcp_f32 v3, v3
    s_nop 0
    v_mul_f32 v9, v9, v3
    v_lshlrev_b32 v3, 2, v0
    ds_write_b32 v3, v9
    s_waitcnt vmcnt(0) lgkmcnt(0)
    s_barrier
    ds_read_b64 v[16:17], v49 offset:0
    s_waitcnt lgkmcnt(0)
    v_cvt_pk_bf16_f32 v16, v16, v16
    v_cvt_pk_bf16_f32 v17, v17, v17
    v_and_b32 v24, v16, v52
    v_and_b32 v25, v16, v53
    v_and_b32 v26, v16, v54
    v_and_b32 v27, v16, v55
    v_and_b32 v28, v17, v52
    v_and_b32 v29, v17, v53
    v_and_b32 v30, v17, v54
    v_and_b32 v31, v17, v55
    v_mfma_f32_16x16x32_bf16 v[40:43], v[24:27], v[56:59], 0
    s_nop 1
    v_mfma_f32_16x16x32_bf16 v[40:43], v[28:31], v[60:63], v[40:43]
    s_nop 7
    v_mov_b32 v44, v40
    v_mov_b32 v45, v41
    v_mov_b32 v46, v42
    v_mov_b32 v47, v43
    s_nop 0
    v_permlane32_swap_b32 v40, v44
    v_permlane32_swap_b32 v41, v45
    v_permlane32_swap_b32 v42, v46
    v_permlane32_swap_b32 v43, v47
    s_nop 0
    v_add_f32_dpp v40, v44, v40 row_ror:8 row_mask:0xf bank_mask:0xf
    v_add_f32_dpp v41, v45, v41 row_ror:8 row_mask:0xf bank_mask:0xf
    v_add_f32_dpp v42, v46, v42 row_ror:8 row_mask:0xf bank_mask:0xf
    v_add_f32_dpp v43, v47, v43 row_ror:8 row_mask:0xf bank_mask:0xf
    s_mov_b32 exec_lo, 0xff00ff
    s_mov_b32 exec_hi, 0x0
    ds_write_b128 v48, v[40:43] offset:2048
    s_mov_b64 exec, -1
    s_waitcnt lgkmcnt(0)
    s_barrier
    s_cmp_lg_u32 s3, 0
    s_cbranch_scc1 d_1
    v_lshlrev_b32 v3, 2, v1
    ds_read_b32 v16, v3 offset:2048
    ds_read_b32 v17, v3 offset:2304
    ds_read_b32 v18, v3 offset:2560
    ds_read_b32 v19, v3 offset:2816
    ds_read_b32 v20, v3 offset:3072
    ds_read_b32 v21, v3 offset:3328
    ds_read_b32 v22, v3 offset:3584
    ds_read_b32 v23, v3 offset:3840
    s_waitcnt lgkmcnt(0)
    v_add_f32 v16, v16, v17
    v_add_f32 v18, v18, v19
    v_add_f32 v20, v20, v21
    v_add_f32 v22, v22, v23
    v_add_f32 v16, v16, v18
    v_add_f32 v20, v20, v22
    v_add_f32 v24, v16, v20
    s_nop 1
    v_mov_b32_dpp v32, v24 quad_perm:[0,0,2,2] row_mask:0xf bank_mask:0xf
    v_mov_b32_dpp v33, v24 quad_perm:[1,1,3,3] row_mask:0xf bank_mask:0xf
    v_mov_b32 v34, s8
    v_mov_b32 v35, s93
    s_lshl_b32 s10, s51, 13
    s_lshl_b32 s11, s52, 9
    s_add_u32 s10, s10, s11
    s_add_u32 s10, s10, 0x8000
    v_lshl_add_u32 v3, v1, 3, s10
    s_mov_b32 exec_lo, 0x55555555
    s_mov_b32 exec_hi, 0x55555555
    global_store_dwordx4 v3, v[32:35], s[46:47] sc1
    s_mov_b64 exec, -1
    s_lshl_b32 s10, s50, 6
    s_add_u32 s10, s10, 0x330000
    v_mov_b32 v246, s8
    v_mov_b32 v247, s93
    v_lshl_add_u32 v248, v1, 0, s10
    s_mov_b32 exec_lo, 0x1
    s_mov_b32 exec_hi, 0x0
    global_store_dwordx4 v248, v[244:247], s[46:47] sc1
    s_mov_b64 exec, -1
ps_2:
d_1:
    s_cmp_ge_u32 s50, 48
    s_cbranch_scc1 L_final
    s_cmp_ge_u32 s50, 32
    s_cbranch_scc1 L_ph5pre
    v_lshrrev_b32 v10, 3, v1
    v_lshlrev_b32 v10, 3, v10
    s_lshl_b32 s10, s3, 6
    v_add_u32 v10, s10, v10
    s_movk_i32 s10, 6144
    v_mul_lo_u32 v10, v10, s10
    v_and_b32 v3, 7, v1
    v_lshl_add_u32 v10, v3, 4, v10
    s_lshl_b32 s10, s50, 7
    s_add_u32 s10, s10, 2048
    v_add_u32 v10, s10, v10
    s_add_u32 s12, s40, 0
    s_addc_u32 s13, s41, 0
    global_load_dwordx4 v[64:67], v10, s[12:13] nt
    s_add_u32 s12, s40, 6144
    s_addc_u32 s13, s41, 0
    global_load_dwordx4 v[68:71], v10, s[12:13] nt
    s_add_u32 s12, s40, 12288
    s_addc_u32 s13, s41, 0
    global_load_dwordx4 v[72:75], v10, s[12:13] nt
    s_add_u32 s12, s40, 18432
    s_addc_u32 s13, s41, 0
    global_load_dwordx4 v[76:79], v10, s[12:13] nt
    s_add_u32 s12, s40, 24576
    s_addc_u32 s13, s41, 0
    global_load_dwordx4 v[80:83], v10, s[12:13] nt
    s_add_u32 s12, s40, 30720
    s_addc_u32 s13, s41, 0
    global_load_dwordx4 v[84:87], v10, s[12:13] nt
    s_add_u32 s12, s40, 36864
    s_addc_u32 s13, s41, 0
    global_load_dwordx4 v[88:91], v10, s[12:13] nt
    s_add_u32 s12, s40, 43008
    s_addc_u32 s13, s41, 0
    global_load_dwordx4 v[92:95], v10, s[12:13] nt
    s_waitcnt vmcnt(0)
    s_barrier
    ds_read_b128 v[16:19], v2 offset:0
    ds_read_b128 v[20:23], v2 offset:16
    s_waitcnt lgkmcnt(0)
    v_cvt_pk_bf16_f32 v16, v16, v16
    v_cvt_pk_bf16_f32 v17, v17, v17
    v_cvt_pk_bf16_f32 v18, v18, v18
    v_cvt_pk_bf16_f32 v19, v19, v19
    v_cvt_pk_bf16_f32 v20, v20, v20
    v_cvt_pk_bf16_f32 v21, v21, v21
    v_cvt_pk_bf16_f32 v22, v22, v22
    v_cvt_pk_bf16_f32 v23, v23, v23
    v_and_b32 v24, v16, v52
    v_and_b32 v25, v16, v53
    v_and_b32 v26, v16, v54
    v_and_b32 v27, v16, v55
    v_and_b32 v28, v17, v52
    v_and_b32 v29, v17, v53
    v_and_b32 v30, v17, v54
    v_and_b32 v31, v17, v55
    v_mfma_f32_16x16x32_bf16 v[40:43], v[24:27], v[64:67], 0
    v_and_b32 v32, v18, v52
    v_and_b32 v33, v18, v53
    v_and_b32 v34, v18, v54
    v_and_b32 v35, v18, v55
    v_mfma_f32_16x16x32_bf16 v[40:43], v[28:31], v[68:71], v[40:43]
    v_and_b32 v24, v19, v52
    v_and_b32 v25, v19, v53
    v_and_b32 v26, v19, v54
    v_and_b32 v27, v19, v55
    v_mfma_f32_16x16x32_bf16 v[40:43], v[32:35], v[72:75], v[40:43]
    v_and_b32 v28, v20, v52
    v_and_b32 v29, v20, v53
    v_and_b32 v30, v20, v54
    v_and_b32 v31, v20, v55
    v_mfma_f32_16x16x32_bf16 v[40:43], v[24:27], v[76:79], v[40:43]
    v_and_b32 v32, v21, v52
    v_and_b32 v33, v21, v53
    v_and_b32 v34, v21, v54
    v_and_b32 v35, v21, v55
    v_mfma_f32_16x16x32_bf16 v[40:43], v[28:31], v[80:83], v[40:43]
    v_and_b32 v24, v22, v52
    v_and_b32 v25, v22, v53
    v_and_b32 v26, v22, v54
    v_and_b32 v27, v22, v55
    v_mfma_f32_16x16x32_bf16 v[40:43], v[32:35], v[84:87], v[40:43]
    v_and_b32 v28, v23, v52
    v_and_b32 v29, v23, v53
    v_and_b32 v30, v23, v54
    v_and_b32 v31, v23, v55
    v_mfma_f32_16x16x32_bf16 v[40:43], v[24:27], v[88:91], v[40:43]
    s_nop 1
    v_mfma_f32_16x16x32_bf16 v[40:43], v[28:31], v[92:95], v[40:43]
    s_nop 7
    v_mov_b32 v44, v40
    v_mov_b32 v45, v41
    v_mov_b32 v46, v42
    v_mov_b32 v47, v43
    s_nop 0
    v_permlane32_swap_b32 v40, v44
    v_permlane32_swap_b32 v41, v45
    v_permlane32_swap_b32 v42, v46
    v_permlane32_swap_b32 v43, v47
    s_nop 0
    v_add_f32_dpp v40, v44, v40 row_ror:8 row_mask:0xf bank_mask:0xf
    v_add_f32_dpp v41, v45, v41 row_ror:8 row_mask:0xf bank_mask:0xf
    v_add_f32_dpp v42, v46, v42 row_ror:8 row_mask:0xf bank_mask:0xf
    v_add_f32_dpp v43, v47, v43 row_ror:8 row_mask:0xf bank_mask:0xf
    s_mov_b32 exec_lo, 0xff00ff
    s_mov_b32 exec_hi, 0x0
    ds_write_b128 v48, v[40:43] offset:2048
    s_mov_b64 exec, -1
    s_waitcnt lgkmcnt(0)
    s_barrier
    s_cmp_lg_u32 s3, 0
    s_cbranch_scc1 d_3
    v_lshlrev_b32 v3, 2, v1
    ds_read_b32 v16, v3 offset:2048
    ds_read_b32 v17, v3 offset:2304
    ds_read_b32 v18, v3 offset:2560
    ds_read_b32 v19, v3 offset:2816
    ds_read_b32 v20, v3 offset:3072
    ds_read_b32 v21, v3 offset:3328
    ds_read_b32 v22, v3 offset:3584
    ds_read_b32 v23, v3 offset:3840
    s_waitcnt lgkmcnt(0)
    v_add_f32 v16, v16, v17
    v_add_f32 v18, v18, v19
    v_add_f32 v20, v20, v21
    v_add_f32 v22, v22, v23
    v_add_f32 v16, v16, v18
    v_add_f32 v20, v20, v22
    v_add_f32 v24, v16, v20
    s_nop 1
    v_mov_b32_dpp v28, v24 quad_perm:[0,0,0,0] row_mask:0xf bank_mask:0xf
    v_mov_b32_dpp v29, v24 quad_perm:[1,1,1,1] row_mask:0xf bank_mask:0xf
    v_mov_b32_dpp v30, v24 quad_perm:[2,2,2,2] row_mask:0xf bank_mask:0xf
    v_mov_b32_dpp v31, v24 quad_perm:[3,3,3,3] row_mask:0xf bank_mask:0xf
    v_cvt_pk_bf16_f32 v32, v28, v29
    v_cvt_pk_bf16_f32 v33, v30, v31
    v_mov_b32 v34, s8
    v_mov_b32 v35, s93
    s_lshl_b32 s10, s50, 8
    s_add_u32 s10, s10, 4096
    v_lshl_add_u32 v3, v1, 2, s10
    s_mov_b32 exec_lo, 0x11111111
    s_mov_b32 exec_hi, 0x11111111
    global_store_dwordx4 v3, v[32:35], s[46:47] sc1
    s_mov_b64 exec, -1
d_3:
L_ph5pre:
    s_cmp_ge_u32 s50, 43
    s_cbranch_scc1 L_end
    s_barrier
    v_lshrrev_b32 v2, 2, v1
    s_lshl_b32 s10, s3, 6
    v_add_u32 v2, s10, v2
    s_movk_i32 s10, 2752
    v_mul_lo_u32 v2, v2, s10
    v_and_b32 v3, 3, v1
    v_lshl_add_u32 v2, v3, 4, v2
    s_lshl_b32 s10, s50, 6
    v_add_u32 v2, s10, v2
    s_mul_i32 s11, s3, 4160
    s_add_u32 s11, s11, 0
    s_add_u32 s12, s30, 0
    s_addc_u32 s13, s31, 0
    s_mov_b32 m0, s11
    s_nop 0
    global_load_lds_dwordx4 v2, s[12:13] nt
    s_add_u32 s11, s11, 1040
    s_add_u32 s12, s30, 44032
    s_addc_u32 s13, s31, 0
    s_mov_b32 m0, s11
    s_nop 0
    global_load_lds_dwordx4 v2, s[12:13] nt
    s_add_u32 s11, s11, 1040
    s_add_u32 s12, s30, 88064
    s_addc_u32 s13, s31, 0
    s_mov_b32 m0, s11
    s_nop 0
    global_load_lds_dwordx4 v2, s[12:13] nt
    s_add_u32 s11, s11, 1040
    s_add_u32 s12, s30, 132096
    s_addc_u32 s13, s31, 0
    s_mov_b32 m0, s11
    s_nop 0
    global_load_lds_dwordx4 v2, s[12:13] nt
    s_add_u32 s11, s11, 1040
    s_lshl_b32 s10, s50, 5
    s_lshl_b32 s11, s3, 2
    s_add_u32 s10, s10, s11
    s_lshl_b32 s10, s10, 10
    v_lshlrev_b32 v2, 4, v1
    v_add_u32 v2, s10, v2
    s_mul_i32 s11, s3, 4160
    s_add_u32 s11, s11, 33280
    s_add_u32 s12, s34, 0
    s_addc_u32 s13, s35, 0
    s_mov_b32 m0, s11
    s_nop 0
    global_load_lds_dwordx4 v2, s[12:13] nt
    s_add_u32 s11, s11, 1040
    s_add_u32 s12, s34, 1024
    s_addc_u32 s13, s35, 0
    s_mov_b32 m0, s11
    s_nop 0
    global_load_lds_dwordx4 v2, s[12:13] nt
    s_add_u32 s11, s11, 1040
    s_add_u32 s12, s34, 2048
    s_addc_u32 s13, s35, 0
    s_mov_b32 m0, s11
    s_nop 0
    global_load_lds_dwordx4 v2, s[12:13] nt
    s_add_u32 s11, s11, 1040
    s_add_u32 s12, s34, 3072
    s_addc_u32 s13, s35, 0
    s_mov_b32 m0, s11
    s_nop 0
    global_load_lds_dwordx4 v2, s[12:13] nt
    s_add_u32 s11, s11, 1040
    v_and_b32 v3, 31, v1
    s_lshl_b32 s10, s50, 6
    v_lshl_add_u32 v3, v3, 1, s10
    global_load_ushort v96, v3, s[32:33]
    v_lshrrev_b32 v97, 5, v1
    v_lshrrev_b32 v3, 3, v1
    v_and_b32 v3, 2, v3
    v_or_b32 v97, v97, v3
    v_lshlrev_b32 v97, 4, v97
    v_and_b32 v3, 15, v1
    s_lshl_b32 s10, s3, 6
    v_add3_u32 v97, v97, v3, s10
    v_lshlrev_b32 v3, 1, v97
    global_load_ushort v98, v3, s[16:17]
    s_mov_b32 s10, 9984
    s_cmp_lg_u32 s3, 0
    s_cbranch_scc1 h_4
    v_mov_b32 v20, s10
    s_mov_b32 exec_lo, 0x1
    s_mov_b32 exec_hi, 0x0
hw_5:
    global_load_dwordx4 v[16:19], v20, s[46:47] sc1
    s_waitcnt vmcnt(0)
    v_xor_b32 v16, s8, v18
    v_xor_b32 v17, s93, v19
    v_or_b32 v16, v16, v17
    v_cmp_ne_u32 vcc, 0, v16
    s_cbranch_vccz hd_6
    s_add_u32 s9, s9, 1
    s_cmp_gt_u32 s9, 400000
    s_cbranch_scc1 L_end
    s_sleep 4
    s_branch hw_5
hd_6:
    s_mov_b64 exec, -1
h_4:
    s_barrier
    s_cmp_ge_u32 s3, 6
    s_cbranch_scc1 d_7
    v_lshlrev_b32 v12, 4, v0
    v_add_u32 v12, 4096, v12
g_8:
    global_load_dwordx4 v[16:19], v12, s[46:47] sc1
    s_waitcnt vmcnt(0)
    v_min_u32 v40, v18, v18
    v_max_u32 v41, v18, v18
    v_min_u32 v42, v19, v19
    v_max_u32 v43, v19, v19
    v_xor_b32 v40, s8, v40
    v_xor_b32 v41, s8, v41
    v_xor_b32 v42, s93, v42
    v_xor_b32 v43, s93, v43
    v_or3_b32 v40, v40, v41, v42
    v_or_b32 v40, v40, v43
    v_cmp_ne_u32 vcc, 0, v40
    s_cbranch_vccz ok_9
    s_add_u32 s9, s9, 1
    s_cmp_gt_u32 s9, 400000
    s_cbranch_scc1 L_end
    s_branch g_8
ok_9:
    v_lshlrev_b32 v3, 3, v0
    v_add_u32 v3, 66560, v3
    ds_write_b64 v3, v[16:17]
d_7:
    s_waitcnt vmcnt(0) lgkmcnt(0)
    s_barrier
    v_lshrrev_b32 v2, 5, v1
    s_lshl_b32 s10, s3, 2
    v_add_u32 v2, s10, v2
    s_movk_i32 s10, 1040
    v_mul_lo_u32 v2, v2, s10
    v_bfe_u32 v3, v1, 4, 1
    v_lshl_add_u32 v2, v3, 9, v2
    v_bfe_u32 v3, v1, 2, 2
    v_lshl_add_u32 v2, v3, 6, v2
    v_and_b32 v3, 3, v1
    v_lshl_add_u32 v2, v3, 3, v2
    ds_read_b64_tr_b16 v[64:65], v2 offset:0
    ds_read_b64_tr_b16 v[66:67], v2 offset:256
    ds_read_b64_tr_b16 v[68:69], v2 offset:32
    ds_read_b64_tr_b16 v[70:71], v2 offset:288
    ds_read_b64_tr_b16 v[72:73], v2 offset:2080
    ds_read_b64_tr_b16 v[74:75], v2 offset:2336
    ds_read_b64_tr_b16 v[76:77], v2 offset:2112
    ds_read_b64_tr_b16 v[78:79], v2 offset:2368
    v_lshrrev_b32 v2, 4, v1
    v_lshlrev_b32 v2, 3, v2
    v_bfe_u32 v3, v1, 2, 2
    v_add_u32 v2, v2, v3
    v_mul_lo_u32 v2, v2, s10
    v_and_b32 v3, 3, v1
    v_lshl_add_u32 v2, v3, 3, v2
    s_lshl_b32 s11, s3, 7
    s_add_u32 s11, s11, 33280
    v_add_u32 v2, s11, v2
    ds_read_b64_tr_b16 v[80:81], v2 offset:0
    ds_read_b64_tr_b16 v[82:83], v2 offset:4160
    ds_read_b64_tr_b16 v[84:85], v2 offset:32
    ds_read_b64_tr_b16 v[86:87], v2 offset:4192
    ds_read_b64_tr_b16 v[88:89], v2 offset:64
    ds_read_b64_tr_b16 v[90:91], v2 offset:4224
    ds_read_b64_tr_b16 v[92:93], v2 offset:96
    ds_read_b64_tr_b16 v[94:95], v2 offset:4256
    v_lshlrev_b32 v3, 1, v97
    v_add_u32 v3, 66560, v3
    ds_read_u16 v99, v3
    v_lshlrev_b32 v3, 4, v1
    v_add_u32 v3, 66560, v3
    ds_read_b128 v[16:19], v3 offset:1024
    ds_read_b128 v[20:23], v3 offset:2048
    s_waitcnt lgkmcnt(0)
    v_lshlrev_b32 v100, 16, v16
    v_and_b32 v101, 0xffff0000, v16
    v_lshlrev_b32 v108, 16, v20
    v_and_b32 v109, 0xffff0000, v20
    v_lshlrev_b32 v102, 16, v17
    v_and_b32 v103, 0xffff0000, v17
    v_lshlrev_b32 v110, 16, v21
    v_and_b32 v111, 0xffff0000, v21
    v_lshlrev_b32 v104, 16, v18
    v_and_b32 v105, 0xffff0000, v18
    v_lshlrev_b32 v112, 16, v22
    v_and_b32 v113, 0xffff0000, v22
    v_lshlrev_b32 v106, 16, v19
    v_and_b32 v107, 0xffff0000, v19
    v_lshlrev_b32 v114, 16, v23
    v_and_b32 v115, 0xffff0000, v23
    v_add_f32 v108, 1.0, v108
    v_add_f32 v109, 1.0, v109
    v_add_f32 v110, 1.0, v110
    v_add_f32 v111, 1.0, v111
    v_add_f32 v112, 1.0, v112
    v_add_f32 v113, 1.0, v113
    v_add_f32 v114, 1.0, v114
    v_add_f32 v115, 1.0, v115
    v_lshlrev_b32 v96, 16, v96
    v_lshlrev_b32 v98, 16, v98
    v_lshlrev_b32 v99, 16, v99
    s_mov_b32 s51, 0x400000
    v_lshrrev_b32 v52, 4, v1
    v_lshlrev_b32 v52, 14, v52
    v_and_b32 v3, 15, v1
    v_lshl_add_u32 v52, v3, 4, v52
    s_lshl_b32 s10, s3, 8
    s_add_u32 s10, s10, s51
    v_add_u32 v52, s10, v52
    s_add_u32 s54, s46, 0
    s_addc_u32 s55, s47, 0
    s_add_u32 s56, s46, 4096
    s_addc_u32 s57, s47, 0
    s_add_u32 s58, s46, 8192
    s_addc_u32 s59, s47, 0
    s_add_u32 s60, s46, 12288
    s_addc_u32 s61, s47, 0
    v_lshlrev_b32 v53, 2, v97
    v_add_u32 v53, 69632, v53
    v_lshlrev_b32 v54, 5, v1
    v_add_u32 v54, 69632, v54
    s_lshl_b32 s10, s3, 10
    s_add_u32 s10, s10, 71680
    v_lshl_add_u32 v55, v1, 4, s10
    v_lshrrev_b32 v3, 4, v1
    s_lshl_b32 s11, s3, 7
    s_add_u32 s10, s10, s11
    v_lshl_add_u32 v56, v3, 4, s10
    v_and_b32 v3, 15, v1
    s_lshl_b32 s10, s3, 7
    s_add_u32 s10, s10, 79872
    v_lshl_add_u32 v57, v3, 2, s10
    v_and_b32 v3, 31, v1
    v_lshlrev_b32 v58, 2, v3
    v_add_u32 v58, 79872, v58
    s_lshl_b32 s10, s3, 6
    s_add_u32 s10, s10, 80896
    v_lshl_add_u32 v59, v3, 1, s10
    v_lshrrev_b32 v3, 4, v1
    v_lshl_add_u32 v60, v3, 4, s10
    v_and_b32 v3, 15, v1
    s_lshl_b32 s10, s50, 11
    s_lshl_b32 s11, s3, 8
    s_add_u32 s10, s10, s11
    s_add_u32 s10, s10, 0x500000
    v_lshl_add_u32 v61, v3, 4, s10
    s_cmp_lg_u32 s3, 0
    s_cbranch_scc1 h_10
    s_lshl_b32 s10, s50, 10
    s_add_u32 s10, s10, 0x320000
    v_lshl_add_u32 v20, v1, 4, s10
    s_mov_b32 exec_lo, 0xffffffff
    s_mov_b32 exec_hi, 0xffffffff
    global_load_dwordx4 v[224:227], v20, s[46:47] sc1
    s_sleep 2
    global_load_dwordx4 v[228:231], v20, s[46:47] sc1
    s_sleep 2
    global_load_dwordx4 v[232:235], v20, s[46:47] sc1
    s_sleep 2
hw_11:
    global_load_dwordx4 v[236:239], v20, s[46:47] sc1
    s_waitcnt vmcnt(3)
    v_xor_b32 v16, s8, v226
    v_xor_b32 v17, s93, v227
    v_or_b32 v16, v16, v17
    v_cmp_ne_u32 vcc, 0, v16
    s_cbranch_vccz hd_12
    s_sleep 1
    global_load_dwordx4 v[224:227], v20, s[46:47] sc1
    s_waitcnt vmcnt(3)
    v_xor_b32 v16, s8, v230
    v_xor_b32 v17, s93, v231
    v_or_b32 v16, v16, v17
    v_cmp_ne_u32 vcc, 0, v16
    s_cbranch_vccz hd_12
    s_sleep 1
    global_load_dwordx4 v[228:231], v20, s[46:47] sc1
    s_waitcnt vmcnt(3)
    v_xor_b32 v16, s8, v234
    v_xor_b32 v17, s93, v235
    v_or_b32 v16, v16, v17
    v_cmp_ne_u32 vcc, 0, v16
    s_cbranch_vccz hd_12
    s_sleep 1
    global_load_dwordx4 v[232:235], v20, s[46:47] sc1
    s_waitcnt vmcnt(3)
    v_xor_b32 v16, s8, v238
    v_xor_b32 v17, s93, v239
    v_or_b32 v16, v16, v17
    v_cmp_ne_u32 vcc, 0, v16
    s_cbranch_vccz hd_12
    s_sleep 1
    s_add_u32 s9, s9, 1
    s_cmp_gt_u32 s9, 400000
    s_cbranch_scc1 L_end
    s_branch hw_11
hd_12:
    s_mov_b64 exec, -1
h_10:
    s_barrier
    s_mov_b32 s53, 0xff
sw_13:
    s_bitcmp1_b32 s53, 0
    s_cbranch_scc0 sk_15
    global_load_dwordx4 v[16:19], v52, s[54:55] offset:0 sc1
sk_15:
    s_bitcmp1_b32 s53, 1
    s_cbranch_scc0 sk_16
    global_load_dwordx4 v[20:23], v52, s[54:55] offset:2048 sc1
sk_16:
    s_bitcmp1_b32 s53, 2
    s_cbranch_scc0 sk_17
    global_load_dwordx4 v[24:27], v52, s[56:57] offset:0 sc1
sk_17:
    s_bitcmp1_b32 s53, 3
    s_cbranch_scc0 sk_18
    global_load_dwordx4 v[28:31], v52, s[56:57] offset:2048 sc1
sk_18:
    s_bitcmp1_b32 s53, 4
    s_cbranch_scc0 sk_19
    global_load_dwordx4 v[32:35], v52, s[58:59] offset:0 sc1
sk_19:
    s_bitcmp1_b32 s53, 5
    s_cbranch_scc0 sk_20
    global_load_dwordx4 v[36:39], v52, s[58:59] offset:2048 sc1
sk_20:
    s_bitcmp1_b32 s53, 6
    s_cbranch_scc0 sk_21
    global_load_dwordx4 v[40:43], v52, s[60:61] offset:0 sc1
sk_21:
    s_bitcmp1_b32 s53, 7
    s_cbranch_scc0 sk_22
    global_load_dwordx4 v[44:47], v52, s[60:61] offset:2048 sc1
sk_22:
    s_waitcnt vmcnt(0)
    v_xor_b32 v120, s8, v18
    v_xor_b32 v121, s93, v19
    v_or_b32 v120, v120, v121
    v_cmp_ne_u32 vcc, 0, v120
    s_cmp_eq_u64 vcc, 0
    s_cselect_b32 s10, 0xfffffffe, -1
    s_and_b32 s53, s53, s10
    v_xor_b32 v120, s8, v22
    v_xor_b32 v121, s93, v23
    v_or_b32 v120, v120, v121
    v_cmp_ne_u32 vcc, 0, v120
    s_cmp_eq_u64 vcc, 0
    s_cselect_b32 s10, 0xfffffffd, -1
    s_and_b32 s53, s53, s10
    v_xor_b32 v120, s8, v26
    v_xor_b32 v121, s93, v27
    v_or_b32 v120, v120, v121
    v_cmp_ne_u32 vcc, 0, v120
    s_cmp_eq_u64 vcc, 0
    s_cselect_b32 s10, 0xfffffffb, -1
    s_and_b32 s53, s53, s10
    v_xor_b32 v120, s8, v30
    v_xor_b32 v121, s93, v31
    v_or_b32 v120, v120, v121
    v_cmp_ne_u32 vcc, 0, v120
    s_cmp_eq_u64 vcc, 0
    s_cselect_b32 s10, 0xfffffff7, -1
    s_and_b32 s53, s53, s10
    v_xor_b32 v120, s8, v34
    v_xor_b32 v121, s93, v35
    v_or_b32 v120, v120, v121
    v_cmp_ne_u32 vcc, 0, v120
    s_cmp_eq_u64 vcc, 0
    s_cselect_b32 s10, 0xffffffef, -1
    s_and_b32 s53, s53, s10
    v_xor_b32 v120, s8, v38
    v_xor_b32 v121, s93, v39
    v_or_b32 v120, v120, v121
    v_cmp_ne_u32 vcc, 0, v120
    s_cmp_eq_u64 vcc, 0
    s_cselect_b32 s10, 0xffffffdf, -1
    s_and_b32 s53, s53, s10
    v_xor_b32 v120, s8, v42
    v_xor_b32 v121, s93, v43
    v_or_b32 v120, v120, v121
    v_cmp_ne_u32 vcc, 0, v120
    s_cmp_eq_u64 vcc, 0
    s_cselect_b32 s10, 0xffffffbf, -1
    s_and_b32 s53, s53, s10
    v_xor_b32 v120, s8, v46
    v_xor_b32 v121, s93, v47
    v_or_b32 v120, v120, v121
    v_cmp_ne_u32 vcc, 0, v120
    s_cmp_eq_u64 vcc, 0
    s_cselect_b32 s10, 0xffffff7f, -1
    s_and_b32 s53, s53, s10
    s_cmp_eq_u32 s53, 0
    s_cbranch_scc1 sd_14
    s_add_u32 s9, s9, 1
    s_cmp_gt_u32 s9, 400000
    s_cbranch_scc1 L_end
    s_branch sw_13
sd_14:
    v_lshlrev_b32 v120, 16, v16
    v_and_b32 v121, 0xffff0000, v16
    v_lshlrev_b32 v122, 16, v17
    v_and_b32 v123, 0xffff0000, v17
    v_lshlrev_b32 v124, 16, v20
    v_and_b32 v125, 0xffff0000, v20
    v_add_f32 v120, v120, v124
    v_add_f32 v121, v121, v125
    v_lshlrev_b32 v124, 16, v21
    v_and_b32 v125, 0xffff0000, v21
    v_add_f32 v122, v122, v124
    v_add_f32 v123, v123, v125
    v_lshlrev_b32 v124, 16, v24
    v_and_b32 v125, 0xffff0000, v24
    v_add_f32 v120, v120, v124
    v_add_f32 v121, v121, v125
    v_lshlrev_b32 v124, 16, v25
    v_and_b32 v125, 0xffff0000, v25
    v_add_f32 v122, v122, v124
    v_add_f32 v123, v123, v125
    v_lshlrev_b32 v124, 16, v28
    v_and_b32 v125, 0xffff0000, v28
    v_add_f32 v120, v120, v124
    v_add_f32 v121, v121, v125
    v_lshlrev_b32 v124, 16, v29
    v_and_b32 v125, 0xffff0000, v29
    v_add_f32 v122, v122, v124
    v_add_f32 v123, v123, v125
    v_lshlrev_b32 v124, 16, v32
    v_and_b32 v125, 0xffff0000, v32
    v_add_f32 v120, v120, v124
    v_add_f32 v121, v121, v125
    v_lshlrev_b32 v124, 16, v33
    v_and_b32 v125, 0xffff0000, v33
    v_add_f32 v122, v122, v124
    v_add_f32 v123, v123, v125
    v_lshlrev_b32 v124, 16, v36
    v_and_b32 v125, 0xffff0000, v36
    v_add_f32 v120, v120, v124
    v_add_f32 v121, v121, v125
    v_lshlrev_b32 v124, 16, v37
    v_and_b32 v125, 0xffff0000, v37
    v_add_f32 v122, v122, v124
    v_add_f32 v123, v123, v125
    v_lshlrev_b32 v124, 16, v40
    v_and_b32 v125, 0xffff0000, v40
    v_add_f32 v120, v120, v124
    v_add_f32 v121, v121, v125
    v_lshlrev_b32 v124, 16, v41
    v_and_b32 v125, 0xffff0000, v41
    v_add_f32 v122, v122, v124
    v_add_f32 v123, v123, v125
    v_lshlrev_b32 v124, 16, v44
    v_and_b32 v125, 0xffff0000, v44
    v_add_f32 v120, v120, v124
    v_add_f32 v121, v121, v125
    v_lshlrev_b32 v124, 16, v45
    v_and_b32 v125, 0xffff0000, v45
    v_add_f32 v122, v122, v124
    v_add_f32 v123, v123, v125
    s_nop 1
    v_permlane32_swap_b32 v120, v121
    v_permlane32_swap_b32 v122, v123
    v_add_f32 v120, v120, v121
    v_add_f32 v122, v122, v123
    s_nop 1
    v_permlane16_swap_b32 v120, v122
    v_add_f32 v120, v120, v122
    v_fma_f32 v120, v99, v120, v98
    v_cvt_pk_bf16_f32 v120, v120, v120
    v_lshlrev_b32 v120, 16, v120
    ds_write_b32 v53, v120
    s_waitcnt lgkmcnt(0)
    s_barrier
    ds_read_b128 v[16:19], v54
    ds_read_b128 v[20:23], v54 offset:16
    s_waitcnt lgkmcnt(0)
    v_readfirstlane_b32 s10, v16
    s_nop 1
    v_subrev_f32 v16, s10, v16
    v_subrev_f32 v17, s10, v17
    v_subrev_f32 v18, s10, v18
    v_subrev_f32 v19, s10, v19
    v_subrev_f32 v20, s10, v20
    v_subrev_f32 v21, s10, v21
    v_subrev_f32 v22, s10, v22
    v_subrev_f32 v23, s10, v23
    v_add_f32 v40, v16, v17
    v_mul_f32 v42, v16, v16
    v_add_f32 v40, v40, v18
    v_add_f32 v40, v40, v19
    v_add_f32 v40, v40, v20
    v_add_f32 v40, v40, v21
    v_add_f32 v40, v40, v22
    v_add_f32 v40, v40, v23
    v_fmac_f32 v42, v17, v17
    v_fmac_f32 v42, v18, v18
    v_fmac_f32 v42, v19, v19
    v_fmac_f32 v42, v20, v20
    v_fmac_f32 v42, v21, v21
    v_fmac_f32 v42, v22, v22
    v_fmac_f32 v42, v23, v23
    s_nop 0
    v_add_f32_dpp v40, v40, v40 row_ror:8 row_mask:0xf bank_mask:0xf
    v_add_f32_dpp v42, v42, v42 row_ror:8 row_mask:0xf bank_mask:0xf
    s_nop 0
    v_add_f32_dpp v40, v40, v40 row_ror:4 row_mask:0xf bank_mask:0xf
    v_add_f32_dpp v42, v42, v42 row_ror:4 row_mask:0xf bank_mask:0xf
    s_nop 0
    v_add_f32_dpp v40, v40, v40 row_ror:2 row_mask:0xf bank_mask:0xf
    v_add_f32_dpp v42, v42, v42 row_ror:2 row_mask:0xf bank_mask:0xf
    s_nop 0
    v_add_f32_dpp v40, v40, v40 row_ror:1 row_mask:0xf bank_mask:0xf
    v_add_f32_dpp v42, v42, v42 row_ror:1 row_mask:0xf bank_mask:0xf
    v_mov_b32 v41, v40
    v_mov_b32 v43, v42
    s_nop 0
    v_permlane16_swap_b32 v41, v40
    v_permlane16_swap_b32 v43, v42
    v_add_f32 v40, v40, v41
    v_add_f32 v42, v42, v43
    v_mov_b32 v41, v40
    v_mov_b32 v43, v42
    s_nop 0
    v_permlane32_swap_b32 v41, v40
    v_permlane32_swap_b32 v43, v42
    v_add_f32 v40, v40, v41
    v_add_f32 v42, v42, v43
    v_mul_f32 v40, 0x3b000000, v40
    v_mul_f32 v42, 0x3b000000, v42
    v_fma_f32 v42, -v40, v40, v42
    v_max_f32 v42, 0, v42
    v_add_f32 v42, 0x3727c5ac, v42
    v_rsq_f32 v42, v42
    v_sub_f32 v16, v16, v40
    v_sub_f32 v17, v17, v40
    v_sub_f32 v18, v18, v40
    v_sub_f32 v19, v19, v40
    v_sub_f32 v20, v20, v40
    v_sub_f32 v21, v21, v40
    v_sub_f32 v22, v22, v40
    v_sub_f32 v23, v23, v40
    v_mul_f32 v16, v16, v42
    v_mul_f32 v17, v17, v42
    v_mul_f32 v18, v18, v42
    v_mul_f32 v19, v19, v42
    v_mul_f32 v20, v20, v42
    v_mul_f32 v21, v21, v42
    v_mul_f32 v22, v22, v42
    v_mul_f32 v23, v23, v42
    v_fma_f32 v16, v16, v108, v100
    v_fma_f32 v17, v17, v109, v101
    v_fma_f32 v18, v18, v110, v102
    v_fma_f32 v19, v19, v111, v103
    v_fma_f32 v20, v20, v112, v104
    v_fma_f32 v21, v21, v113, v105
    v_fma_f32 v22, v22, v114, v106
    v_fma_f32 v23, v23, v115, v107
    s_nop 0
    v_readfirstlane_b32 s10, v16
    s_nop 1
    v_subrev_f32 v16, s10, v16
    v_subrev_f32 v17, s10, v17
    v_subrev_f32 v18, s10, v18
    v_subrev_f32 v19, s10, v19
    v_subrev_f32 v20, s10, v20
    v_subrev_f32 v21, s10, v21
    v_subrev_f32 v22, s10, v22
    v_subrev_f32 v23, s10, v23
    v_add_f32 v40, v16, v17
    v_mul_f32 v42, v16, v16
    v_add_f32 v40, v40, v18
    v_add_f32 v40, v40, v19
    v_add_f32 v40, v40, v20
    v_add_f32 v40, v40, v21
    v_add_f32 v40, v40, v22
    v_add_f32 v40, v40, v23
    v_fmac_f32 v42, v17, v17
    v_fmac_f32 v42, v18, v18
    v_fmac_f32 v42, v19, v19
    v_fmac_f32 v42, v20, v20
    v_fmac_f32 v42, v21, v21
    v_fmac_f32 v42, v22, v22
    v_fmac_f32 v42, v23, v23
    s_nop 0
    v_add_f32_dpp v40, v40, v40 row_ror:8 row_mask:0xf bank_mask:0xf
    v_add_f32_dpp v42, v42, v42 row_ror:8 row_mask:0xf bank_mask:0xf
    s_nop 0
    v_add_f32_dpp v40, v40, v40 row_ror:4 row_mask:0xf bank_mask:0xf
    v_add_f32_dpp v42, v42, v42 row_ror:4 row_mask:0xf bank_mask:0xf
    s_nop 0
    v_add_f32_dpp v40, v40, v40 row_ror:2 row_mask:0xf bank_mask:0xf
    v_add_f32_dpp v42, v42, v42 row_ror:2 row_mask:0xf bank_mask:0xf
    s_nop 0
    v_add_f32_dpp v40, v40, v40 row_ror:1 row_mask:0xf bank_mask:0xf
    v_add_f32_dpp v42, v42, v42 row_ror:1 row_mask:0xf bank_mask:0xf
    v_mov_b32 v41, v40
    v_mov_b32 v43, v42
    s_nop 0
    v_permlane16_swap_b32 v41, v40
    v_permlane16_swap_b32 v43, v42
    v_add_f32 v40, v40, v41
    v_add_f32 v42, v42, v43
    v_mov_b32 v41, v40
    v_mov_b32 v43, v42
    s_nop 0
    v_permlane32_swap_b32 v41, v40
    v_permlane32_swap_b32 v43, v42
    v_add_f32 v40, v40, v41
    v_add_f32 v42, v42, v43
    v_mul_f32 v40, 0x3b000000, v40
    v_mul_f32 v42, 0x3b000000, v42
    v_fma_f32 v42, -v40, v40, v42
    v_max_f32 v42, 0, v42
    v_add_f32 v42, 0x3727c5ac, v42
    v_rsq_f32 v42, v42
    v_sub_f32 v16, v16, v40
    v_sub_f32 v17, v17, v40
    v_sub_f32 v18, v18, v40
    v_sub_f32 v19, v19, v40
    v_sub_f32 v20, v20, v40
    v_sub_f32 v21, v21, v40
    v_sub_f32 v22, v22, v40
    v_sub_f32 v23, v23, v40
    v_mul_f32 v16, v16, v42
    v_mul_f32 v17, v17, v42
    v_mul_f32 v18, v18, v42
    v_mul_f32 v19, v19, v42
    v_mul_f32 v20, v20, v42
    v_mul_f32 v21, v21, v42
    v_mul_f32 v22, v22, v42
    v_mul_f32 v23, v23, v42
    v_cvt_pk_bf16_f32 v24, v16, v17
    v_cvt_pk_bf16_f32 v25, v18, v19
    v_cvt_pk_bf16_f32 v26, v20, v21
    v_cvt_pk_bf16_f32 v27, v22, v23
    ds_write_b128 v55, v[24:27]
    s_waitcnt lgkmcnt(0)
    ds_read_b128 v[16:19], v56
    ds_read_b128 v[20:23], v56 offset:64
    s_waitcnt lgkmcnt(1)
    v_mfma_f32_16x16x32_bf16 v[24:27], v[16:19], v[64:67], 0
    v_mfma_f32_16x16x32_bf16 v[28:31], v[16:19], v[68:71], 0
    s_waitcnt lgkmcnt(0)
    v_mfma_f32_16x16x32_bf16 v[24:27], v[20:23], v[72:75], v[24:27]
    v_mfma_f32_16x16x32_bf16 v[28:31], v[20:23], v[76:79], v[28:31]
    s_nop 7
    s_mov_b32 exec_lo, 0xffff
    s_mov_b32 exec_hi, 0x0
    ds_write_b32 v57, v24
    ds_write_b32 v57, v28 offset:64
    s_mov_b64 exec, -1
    s_waitcnt lgkmcnt(0)
    s_barrier
    ds_read_b32 v16, v58 offset:0
    ds_read_b32 v17, v58 offset:128
    ds_read_b32 v18, v58 offset:256
    ds_read_b32 v19, v58 offset:384
    ds_read_b32 v20, v58 offset:512
    ds_read_b32 v21, v58 offset:640
    ds_read_b32 v22, v58 offset:768
    ds_read_b32 v23, v58 offset:896
    s_waitcnt lgkmcnt(0)
    v_add_f32 v16, v16, v17
    v_add_f32 v18, v18, v19
    v_add_f32 v20, v20, v21
    v_add_f32 v22, v22, v23
    v_add_f32 v16, v16, v18
    v_add_f32 v20, v20, v22
    v_add_f32 v24, v16, v20
    v_add_f32 v24, v24, v96
    v_mul_f32 v20, v24, v24
    v_mul_f32 v20, 0x3d372713, v20
    v_fma_f32 v20, v20, v24, v24
    v_mul_f32 v20, 0xc0135761, v20
    v_exp_f32 v20, v20
    s_nop 0
    v_add_f32 v20, 1.0, v20
    v_rcp_f32 v20, v20
    s_nop 0
    v_mul_f32 v24, v24, v20
    v_cvt_pk_bf16_f32 v24, v24, v24
    ds_write_b16 v59, v24
    s_waitcnt lgkmcnt(0)
    ds_read_b128 v[16:19], v60
    s_waitcnt lgkmcnt(0)
    v_mfma_f32_16x16x32_bf16 v[24:27], v[16:19], v[80:83], 0
    v_mfma_f32_16x16x32_bf16 v[28:31], v[16:19], v[84:87], 0
    v_mfma_f32_16x16x32_bf16 v[32:35], v[16:19], v[88:91], 0
    v_mfma_f32_16x16x32_bf16 v[36:39], v[16:19], v[92:95], 0
    s_nop 7
    v_cvt_pk_bf16_f32 v16, v24, v28
    v_cvt_pk_bf16_f32 v17, v32, v36
    v_mov_b32 v18, s8
    v_mov_b32 v19, s93
    s_mov_b32 exec_lo, 0xffff
    s_mov_b32 exec_hi, 0x0
    s_and_b64 exec, exec, s[96:97]
    global_store_dwordx4 v61, v[16:19], s[46:47] sc1
    s_mov_b64 exec, -1
    s_branch L_end
L_final:
    s_barrier
    s_sub_u32 s52, s50, 48
    v_lshrrev_b32 v3, 3, v0
    v_lshlrev_b32 v72, 11, v3
    v_and_b32 v2, 7, v0
    v_lshl_add_u32 v72, v2, 4, v72
    s_lshl_b32 s10, s52, 7
    v_add_u32 v72, s10, v72
    v_cmp_gt_u32 vcc, 32, v3
    s_mov_b64 s[54:55], vcc
    v_cmp_gt_u32 vcc, 43, v3
    s_mov_b64 s[56:57], vcc
    v_lshrrev_b32 v48, 5, v1
    v_lshrrev_b32 v3, 3, v1
    v_and_b32 v3, 2, v3
    v_or_b32 v48, v48, v3
    v_lshl_add_u32 v48, v2, 2, v48
    s_lshl_b32 s10, s3, 7
    v_lshl_add_u32 v48, v48, 2, s10
    v_and_b32 v3, 3, v1
    v_lshlrev_b32 v70, 4, v3
    v_bfe_u32 v3, v1, 2, 3
    v_add_u32 v70, v70, v3
    s_lshr_b32 s10, s52, 1
    s_lshl_b32 s10, s10, 6
    s_and_b32 s11, s52, 1
    s_lshl_b32 s11, s11, 3
    s_add_u32 s10, s10, s11
    v_add_u32 v70, s10, v70
    v_lshlrev_b32 v71, 1, v70
    global_load_ushort v64, v71, s[16:17]
    global_load_ushort v65, v71, s[36:37]
    s_waitcnt vmcnt(0)
    v_readfirstlane_b32 s8, v253
    s_nop 3
    s_add_u32 s8, s8, 1
    s_xor_b32 s93, s8, 0x5bd1e995
    s_cmp_lg_u32 s3, 0
    s_cbranch_scc1 d_23
    s_mov_b32 s10, 12032
    v_mov_b32 v20, s10
    s_mov_b32 exec_lo, 0x1
    s_mov_b32 exec_hi, 0x0
hw_24:
    global_load_dwordx4 v[16:19], v20, s[46:47] sc1
    s_waitcnt vmcnt(0)
    v_xor_b32 v16, s8, v18
    v_xor_b32 v17, s93, v19
    v_or_b32 v16, v16, v17
    v_cmp_ne_u32 vcc, 0, v16
    s_cbranch_vccz hd_25
    s_add_u32 s9, s9, 1
    s_cmp_gt_u32 s9, 400000
    s_cbranch_scc1 L_end
    s_sleep 4
    s_branch hw_24
hd_25:
    s_mov_b64 exec, -1
    v_lshrrev_b32 v3, 2, v70
    v_lshlrev_b32 v3, 4, v3
    v_add_u32 v10, 4096, v3
    v_add_u32 v11, 10240, v3
g_26:
    global_load_dwordx4 v[16:19], v10, s[46:47] sc1
    global_load_dwordx4 v[20:23], v11, s[46:47] sc1
    s_waitcnt vmcnt(0)
    v_min_u32 v40, v18, v22
    v_max_u32 v41, v18, v22
    v_min_u32 v42, v19, v23
    v_max_u32 v43, v19, v23
    v_xor_b32 v40, s8, v40
    v_xor_b32 v41, s8, v41
    v_xor_b32 v42, s93, v42
    v_xor_b32 v43, s93, v43
    v_or3_b32 v40, v40, v41, v42
    v_or_b32 v40, v40, v43
    v_cmp_ne_u32 vcc, 0, v40
    s_cbranch_vccz ok_27
    s_add_u32 s9, s9, 1
    s_cmp_gt_u32 s9, 400000
    s_cbranch_scc1 L_end
    s_branch g_26
ok_27:
    v_and_b32 v3, 2, v70
    v_cmp_ne_u32 vcc, 0, v3
    s_nop 1
    v_cndmask_b32 v66, v16, v17, vcc
    v_cndmask_b32 v67, v20, v21, vcc
    v_and_b32 v3, 1, v70
    v_lshlrev_b32 v3, 4, v3
    v_lshrrev_b32 v66, v3, v66
    v_lshrrev_b32 v67, v3, v67
    v_lshlrev_b32 v64, 16, v64
    v_lshlrev_b32 v65, 16, v65
    v_lshlrev_b32 v66, 16, v66
    v_lshlrev_b32 v67, 16, v67
d_23:
    s_cmp_lg_u32 s3, 0
    s_cbranch_scc1 h_28
    s_add_u32 s10, s52, 43
    s_lshl_b32 s10, s10, 10
    s_add_u32 s10, s10, 0x320000
    v_lshl_add_u32 v20, v1, 4, s10
    s_mov_b32 exec_lo, 0xffffffff
    s_mov_b32 exec_hi, 0xffffffff
    global_load_dwordx4 v[224:227], v20, s[46:47] sc1
    s_sleep 2
    global_load_dwordx4 v[228:231], v20, s[46:47] sc1
    s_sleep 2
    global_load_dwordx4 v[232:235], v20, s[46:47] sc1
    s_sleep 2
hw_29:
    global_load_dwordx4 v[236:239], v20, s[46:47] sc1
    s_waitcnt vmcnt(3)
    v_xor_b32 v16, s8, v226
    v_xor_b32 v17, s93, v227
    v_or_b32 v16, v16, v17
    v_cmp_ne_u32 vcc, 0, v16
    s_cbranch_vccz hd_30
    s_sleep 1
    global_load_dwordx4 v[224:227], v20, s[46:47] sc1
    s_waitcnt vmcnt(3)
    v_xor_b32 v16, s8, v230
    v_xor_b32 v17, s93, v231
    v_or_b32 v16, v16, v17
    v_cmp_ne_u32 vcc, 0, v16
    s_cbranch_vccz hd_30
    s_sleep 1
    global_load_dwordx4 v[228:231], v20, s[46:47] sc1
    s_waitcnt vmcnt(3)
    v_xor_b32 v16, s8, v234
    v_xor_b32 v17, s93, v235
    v_or_b32 v16, v16, v17
    v_cmp_ne_u32 vcc, 0, v16
    s_cbranch_vccz hd_30
    s_sleep 1
    global_load_dwordx4 v[232:235], v20, s[46:47] sc1
    s_waitcnt vmcnt(3)
    v_xor_b32 v16, s8, v238
    v_xor_b32 v17, s93, v239
    v_or_b32 v16, v16, v17
    v_cmp_ne_u32 vcc, 0, v16
    s_cbranch_vccz hd_30
    s_sleep 1
    s_add_u32 s9, s9, 1
    s_cmp_gt_u32 s9, 400000
    s_cbranch_scc1 L_end
    s_branch hw_29
hd_30:
    s_mov_b64 exec, -1
h_28:
    s_barrier
    v_add_u32 v10, 0x400000, v72
    v_mov_b32 v16, 0
    v_mov_b32 v17, 0
    v_mov_b32 v18, s8
    v_mov_b32 v19, s93
    s_cmp_eq_u64 s[54:55], 0
    s_cbranch_scc1 r_32
g_31:
    s_mov_b64 exec, s[54:55]
    global_load_dwordx4 v[16:19], v10, s[46:47] sc1
    s_mov_b64 exec, -1
    s_waitcnt vmcnt(0)
    v_min_u32 v40, v18, v18
    v_max_u32 v41, v18, v18
    v_min_u32 v42, v19, v19
    v_max_u32 v43, v19, v19
    v_xor_b32 v40, s8, v40
    v_xor_b32 v41, s8, v41
    v_xor_b32 v42, s93, v42
    v_xor_b32 v43, s93, v43
    v_or3_b32 v40, v40, v41, v42
    v_or_b32 v40, v40, v43
    v_cmp_ne_u32 vcc, 0, v40
    s_cbranch_vccz ok_33
    s_add_u32 s9, s9, 1
    s_cmp_gt_u32 s9, 400000
    s_cbranch_scc1 L_end
    s_branch g_31
ok_33:
r_32:
    v_lshlrev_b32 v20, 16, v16
    v_and_b32 v21, 0xffff0000, v16
    v_lshlrev_b32 v22, 16, v17
    v_and_b32 v23, 0xffff0000, v17
    s_nop 1
    v_permlane32_swap_b32 v20, v21
    v_permlane32_swap_b32 v22, v23
    v_add_f32 v20, v20, v21
    v_add_f32 v22, v22, v23
    s_nop 1
    v_permlane16_swap_b32 v20, v22
    v_add_f32 v20, v20, v22
    s_nop 1
    v_add_f32_dpp v20, v20, v20 row_ror:8 row_mask:0xf bank_mask:0xf
    s_mov_b32 exec_lo, 0xff00ff
    s_mov_b32 exec_hi, 0xff00ff
    ds_write_b32 v48, v20 offset:0
    s_mov_b64 exec, -1
    s_waitcnt lgkmcnt(0)
    s_barrier
    s_cmp_lg_u32 s3, 0
    s_cbranch_scc1 rw_34
    v_and_b32 v3, 31, v1
    v_lshlrev_b32 v3, 2, v3
    ds_read_b32 v24, v3 offset:0
    ds_read_b32 v25, v3 offset:128
    ds_read_b32 v26, v3 offset:256
    ds_read_b32 v27, v3 offset:384
    ds_read_b32 v28, v3 offset:512
    ds_read_b32 v29, v3 offset:640
    ds_read_b32 v30, v3 offset:768
    ds_read_b32 v31, v3 offset:896
    s_waitcnt lgkmcnt(0)
    v_add_f32 v24, v24, v25
    v_add_f32 v26, v26, v27
    v_add_f32 v28, v28, v29
    v_add_f32 v30, v30, v31
    v_add_f32 v24, v24, v26
    v_add_f32 v28, v28, v30
    v_add_f32 v16, v24, v28
    v_fma_f32 v68, v66, v16, v64
    v_cvt_pk_bf16_f32 v68, v68, v68
    v_lshlrev_b32 v68, 16, v68
rw_34:
    v_add_u32 v10, 0x500000, v72
    v_mov_b32 v16, 0
    v_mov_b32 v17, 0
    v_mov_b32 v18, s8
    v_mov_b32 v19, s93
    s_cmp_eq_u64 s[56:57], 0
    s_cbranch_scc1 r_36
g_35:
    s_mov_b64 exec, s[56:57]
    global_load_dwordx4 v[16:19], v10, s[46:47] sc1
    s_mov_b64 exec, -1
    s_waitcnt vmcnt(0)
    v_min_u32 v40, v18, v18
    v_max_u32 v41, v18, v18
    v_min_u32 v42, v19, v19
    v_max_u32 v43, v19, v19
    v_xor_b32 v40, s8, v40
    v_xor_b32 v41, s8, v41
    v_xor_b32 v42, s93, v42
    v_xor_b32 v43, s93, v43
    v_or3_b32 v40, v40, v41, v42
    v_or_b32 v40, v40, v43
    v_cmp_ne_u32 vcc, 0, v40
    s_cbranch_vccz ok_37
    s_add_u32 s9, s9, 1
    s_cmp_gt_u32 s9, 400000
    s_cbranch_scc1 L_end
    s_branch g_35
ok_37:
r_36:
    v_lshlrev_b32 v20, 16, v16
    v_and_b32 v21, 0xffff0000, v16
    v_lshlrev_b32 v22, 16, v17
    v_and_b32 v23, 0xffff0000, v17
    s_nop 1
    v_permlane32_swap_b32 v20, v21
    v_permlane32_swap_b32 v22, v23
    v_add_f32 v20, v20, v21
    v_add_f32 v22, v22, v23
    s_nop 1
    v_permlane16_swap_b32 v20, v22
    v_add_f32 v20, v20, v22
    s_nop 1
    v_add_f32_dpp v20, v20, v20 row_ror:8 row_mask:0xf bank_mask:0xf
    s_mov_b32 exec_lo, 0xff00ff
    s_mov_b32 exec_hi, 0xff00ff
    ds_write_b32 v48, v20 offset:1024
    s_mov_b64 exec, -1
    s_waitcnt lgkmcnt(0)
    s_barrier
    s_cmp_lg_u32 s3, 0
    s_cbranch_scc1 rw_38
    v_and_b32 v3, 31, v1
    v_lshlrev_b32 v3, 2, v3
    ds_read_b32 v24, v3 offset:1024
    ds_read_b32 v25, v3 offset:1152
    ds_read_b32 v26, v3 offset:1280
    ds_read_b32 v27, v3 offset:1408
    ds_read_b32 v28, v3 offset:1536
    ds_read_b32 v29, v3 offset:1664
    ds_read_b32 v30, v3 offset:1792
    ds_read_b32 v31, v3 offset:1920
    s_waitcnt lgkmcnt(0)
    v_add_f32 v24, v24, v25
    v_add_f32 v26, v26, v27
    v_add_f32 v28, v28, v29
    v_add_f32 v30, v30, v31
    v_add_f32 v24, v24, v26
    v_add_f32 v28, v28, v30
    v_add_f32 v16, v24, v28
    v_add_f32 v16, v16, v65
    v_fma_f32 v16, v67, v16, v68
    v_cvt_pk_bf16_f32 v16, v16, v16
    s_mov_b32 exec_lo, 0xffffffff
    s_mov_b32 exec_hi, 0x0
    global_store_short v71, v16, s[42:43]
    s_cmp_lg_u32 s52, 0
    s_cbranch_scc1 rw_38
    s_mov_b32 exec_lo, 0x1
    s_mov_b32 exec_hi, 0x0
    v_mov_b32 v3, 0x600000
    v_mov_b32 v24, s8
    global_store_dword v3, v24, s[46:47] sc1
rw_38:
    s_mov_b64 exec, -1
    s_branch L_end
L_roleB:
    s_lshl_b32 s50, s48, 1
    s_add_u32 s50, s50, s49
    s_lshl_b32 s50, s50, 11
    s_add_u32 s50, s50, 0x10000
    s_cmp_ge_u32 s3, 4
    s_cbranch_scc1 L_Bload
    v_lshlrev_b32 v2, 4, v1
    global_load_dwordx4 v[128:131], v2, s[16:17]
    v_lshlrev_b32 v2, 2, v0
    global_load_dword v132, v2, s[16:17]
    s_waitcnt vmcnt(0)
    v_readfirstlane_b32 s8, v253
    s_nop 3
    s_add_u32 s8, s8, 1
    s_xor_b32 s93, s8, 0x5bd1e995
    v_lshlrev_b32 v16, 16, v128
    v_and_b32 v17, 0xffff0000, v128
    v_lshlrev_b32 v18, 16, v129
    v_and_b32 v19, 0xffff0000, v129
    v_lshlrev_b32 v20, 16, v130
    v_and_b32 v21, 0xffff0000, v130
    v_lshlrev_b32 v22, 16, v131
    v_and_b32 v23, 0xffff0000, v131
    v_lshlrev_b32 v134, 16, v132
    v_and_b32 v135, 0xffff0000, v132
    v_add_f32 v40, v16, v17
    v_add_f32 v40, v40, v18
    v_add_f32 v40, v40, v19
    v_add_f32 v40, v40, v20
    v_add_f32 v40, v40, v21
    v_add_f32 v40, v40, v22
    v_add_f32 v40, v40, v23
    s_nop 1
    v_add_f32_dpp v40, v40, v40 row_ror:8 row_mask:0xf bank_mask:0xf
    s_nop 1
    v_add_f32_dpp v40, v40, v40 row_ror:4 row_mask:0xf bank_mask:0xf
    s_nop 1
    v_add_f32_dpp v40, v40, v40 row_ror:2 row_mask:0xf bank_mask:0xf
    s_nop 1
    v_add_f32_dpp v40, v40, v40 row_ror:1 row_mask:0xf bank_mask:0xf
    v_mov_b32 v41, v40
    s_nop 1
    v_permlane16_swap_b32 v41, v40
    v_add_f32 v40, v40, v41
    v_mov_b32 v41, v40
    s_nop 1
    v_permlane32_swap_b32 v41, v40
    v_add_f32 v40, v40, v41
    v_mul_f32 v40, 0x3b000000, v40
    v_sub_f32 v16, v16, v40
    v_sub_f32 v17, v17, v40
    v_sub_f32 v18, v18, v40
    v_sub_f32 v19, v19, v40
    v_sub_f32 v20, v20, v40
    v_sub_f32 v21, v21, v40
    v_sub_f32 v22, v22, v40
    v_sub_f32 v23, v23, v40
    v_sub_f32 v134, v134, v40
    v_sub_f32 v135, v135, v40
    v_mul_f32 v42, v16, v16
    v_fmac_f32 v42, v17, v17
    v_fmac_f32 v42, v18, v18
    v_fmac_f32 v42, v19, v19
    v_fmac_f32 v42, v20, v20
    v_fmac_f32 v42, v21, v21
    v_fmac_f32 v42, v22, v22
    v_fmac_f32 v42, v23, v23
    s_nop 1
    v_add_f32_dpp v42, v42, v42 row_ror:8 row_mask:0xf bank_mask:0xf
    s_nop 1
    v_add_f32_dpp v42, v42, v42 row_ror:4 row_mask:0xf bank_mask:0xf
    s_nop 1
    v_add_f32_dpp v42, v42, v42 row_ror:2 row_mask:0xf bank_mask:0xf
    s_nop 1
    v_add_f32_dpp v42, v42, v42 row_ror:1 row_mask:0xf bank_mask:0xf
    v_mov_b32 v41, v42
    s_nop 1
    v_permlane16_swap_b32 v41, v42
    v_add_f32 v42, v42, v41
    v_mov_b32 v41, v42
    s_nop 1
    v_permlane32_swap_b32 v41, v42
    v_add_f32 v42, v42, v41
    v_mov_b32 v41, 0x3727c5ac
    v_fmac_f32 v41, 0x3b000000, v42
    v_rsq_f32 v41, v41
    s_nop 0
    v_mul_f32 v134, v134, v41
    v_mul_f32 v135, v135, v41
    s_lshl_b32 s10, s48, 11
    s_lshl_b32 s11, s49, 10
    s_add_u32 s10, s10, s11
    s_add_u32 s10, s10, 0x340000
    v_lshlrev_b32 v3, 4, v0
    v_add_u32 v3, 0x8000, v3
    s_add_u32 s54, s46, 0
    s_addc_u32 s55, s47, 0
    s_add_u32 s62, s46, 4096
    s_addc_u32 s63, s47, 0
    s_add_u32 s56, s46, 8192
    s_addc_u32 s57, s47, 0
    s_add_u32 s64, s46, 12288
    s_addc_u32 s65, s47, 0
    s_add_u32 s58, s46, 16384
    s_addc_u32 s59, s47, 0
    s_add_u32 s66, s46, 20480
    s_addc_u32 s67, s47, 0
    s_add_u32 s60, s46, 24576
    s_addc_u32 s61, s47, 0
    s_add_u32 s68, s46, 28672
    s_addc_u32 s69, s47, 0
    s_mov_b32 s53, 0xff
sw_39:
    s_bitcmp1_b32 s53, 0
    s_cbranch_scc0 sk_41
    global_load_dwordx4 v[16:19], v3, s[54:55] sc1
sk_41:
    s_bitcmp1_b32 s53, 1
    s_cbranch_scc0 sk_42
    global_load_dwordx4 v[32:35], v3, s[62:63] sc1
sk_42:
    s_bitcmp1_b32 s53, 2
    s_cbranch_scc0 sk_43
    global_load_dwordx4 v[20:23], v3, s[56:57] sc1
sk_43:
    s_bitcmp1_b32 s53, 3
    s_cbranch_scc0 sk_44
    global_load_dwordx4 v[36:39], v3, s[64:65] sc1
sk_44:
    s_bitcmp1_b32 s53, 4
    s_cbranch_scc0 sk_45
    global_load_dwordx4 v[24:27], v3, s[58:59] sc1
sk_45:
    s_bitcmp1_b32 s53, 5
    s_cbranch_scc0 sk_46
    global_load_dwordx4 v[40:43], v3, s[66:67] sc1
sk_46:
    s_bitcmp1_b32 s53, 6
    s_cbranch_scc0 sk_47
    global_load_dwordx4 v[28:31], v3, s[60:61] sc1
sk_47:
    s_bitcmp1_b32 s53, 7
    s_cbranch_scc0 sk_48
    global_load_dwordx4 v[44:47], v3, s[68:69] sc1
sk_48:
    s_waitcnt vmcnt(0)
    v_xor_b32 v136, s8, v18
    v_xor_b32 v137, s93, v19
    v_or_b32 v136, v136, v137
    v_cmp_ne_u32 vcc, 0, v136
    s_cmp_eq_u64 vcc, 0
    s_cselect_b32 s10, 0xfffffffe, -1
    s_and_b32 s53, s53, s10
    v_xor_b32 v136, s8, v34
    v_xor_b32 v137, s93, v35
    v_or_b32 v136, v136, v137
    v_cmp_ne_u32 vcc, 0, v136
    s_cmp_eq_u64 vcc, 0
    s_cselect_b32 s10, 0xfffffffd, -1
    s_and_b32 s53, s53, s10
    v_xor_b32 v136, s8, v22
    v_xor_b32 v137, s93, v23
    v_or_b32 v136, v136, v137
    v_cmp_ne_u32 vcc, 0, v136
    s_cmp_eq_u64 vcc, 0
    s_cselect_b32 s10, 0xfffffffb, -1
    s_and_b32 s53, s53, s10
    v_xor_b32 v136, s8, v38
    v_xor_b32 v137, s93, v39
    v_or_b32 v136, v136, v137
    v_cmp_ne_u32 vcc, 0, v136
    s_cmp_eq_u64 vcc, 0
    s_cselect_b32 s10, 0xfffffff7, -1
    s_and_b32 s53, s53, s10
    v_xor_b32 v136, s8, v26
    v_xor_b32 v137, s93, v27
    v_or_b32 v136, v136, v137
    v_cmp_ne_u32 vcc, 0, v136
    s_cmp_eq_u64 vcc, 0
    s_cselect_b32 s10, 0xffffffef, -1
    s_and_b32 s53, s53, s10
    v_xor_b32 v136, s8, v42
    v_xor_b32 v137, s93, v43
    v_or_b32 v136, v136, v137
    v_cmp_ne_u32 vcc, 0, v136
    s_cmp_eq_u64 vcc, 0
    s_cselect_b32 s10, 0xffffffdf, -1
    s_and_b32 s53, s53, s10
    v_xor_b32 v136, s8, v30
    v_xor_b32 v137, s93, v31
    v_or_b32 v136, v136, v137
    v_cmp_ne_u32 vcc, 0, v136
    s_cmp_eq_u64 vcc, 0
    s_cselect_b32 s10, 0xffffffbf, -1
    s_and_b32 s53, s53, s10
    v_xor_b32 v136, s8, v46
    v_xor_b32 v137, s93, v47
    v_or_b32 v136, v136, v137
    v_cmp_ne_u32 vcc, 0, v136
    s_cmp_eq_u64 vcc, 0
    s_cselect_b32 s10, 0xffffff7f, -1
    s_and_b32 s53, s53, s10
    s_cmp_eq_u32 s53, 0
    s_cbranch_scc1 sd_40
    s_add_u32 s9, s9, 1
    s_cmp_gt_u32 s9, 400000
    s_cbranch_scc1 L_end
    s_branch sw_39
sd_40:
    v_add_f32 v16, v16, v20
    v_add_f32 v24, v24, v28
    v_add_f32 v16, v16, v24
    v_add_f32 v17, v17, v21
    v_add_f32 v25, v25, v29
    v_add_f32 v17, v17, v25
    v_cvt_pk_bf16_f32 v16, v16, v17
    v_lshlrev_b32 v18, 16, v16
    v_and_b32 v19, 0xffff0000, v16
    v_add_f32 v32, v32, v36
    v_add_f32 v40, v40, v44
    v_add_f32 v32, v32, v40
    v_add_f32 v33, v33, v37
    v_add_f32 v41, v41, v45
    v_add_f32 v33, v33, v41
    v_cvt_pk_bf16_f32 v32, v32, v33
    v_lshlrev_b32 v34, 16, v32
    v_and_b32 v35, 0xffff0000, v32
    v_fma_f32 v34, v134, v34, v134
    v_add_f32 v34, v34, v18
    v_fma_f32 v35, v135, v35, v135
    v_add_f32 v35, v35, v19
    v_lshlrev_b32 v3, 3, v0
    ds_write_b64 v3, v[34:35]
    s_waitcnt lgkmcnt(0)
    s_barrier
    s_barrier
L_B2:
    v_lshlrev_b32 v3, 2, v1
    ds_read_b32 v16, v3 offset:2048
    ds_read_b32 v17, v3 offset:2304
    ds_read_b32 v18, v3 offset:2560
    ds_read_b32 v19, v3 offset:2816
    s_lshl_b32 s10, s3, 7
    v_lshl_add_u32 v56, v1, 1, s10
    v_lshrrev_b32 v3, 4, v1
    v_lshl_add_u32 v57, v3, 4, s10
    s_lshl_b32 s10, s3, 8
    s_add_u32 s10, s10, s50
    v_lshl_add_u32 v58, v3, 4, s10
    v_bfe_u32 v3, v1, 3, 1
    s_lshl_b32 s10, s3, 3
    v_add_u32 v3, s10, v3
    s_movk_i32 s10, 1040
    v_mul_lo_u32 v59, v3, s10
    v_and_b32 v3, 7, v1
    v_lshl_add_u32 v59, v3, 7, v59
    v_lshrrev_b32 v11, 4, v1
    v_xor_b32 v3, v3, v11
    v_add_u32 v59, 8192, v59
    v_xor_b32 v11, 4, v3
    v_lshl_add_u32 v60, v11, 4, v59
    v_lshl_add_u32 v59, v3, 4, v59
    s_waitcnt lgkmcnt(0)
    v_add_f32 v16, v16, v17
    v_add_f32 v18, v18, v19
    v_add_f32 v24, v16, v18
    v_cvt_pk_bf16_f32 v24, v24, v24
    ds_write_b16 v56, v24 offset:4096
    s_lshr_b32 s10, s48, 4
    s_lshl_b32 s10, s10, 9
    s_and_b32 s11, s48, 15
    s_lshl_b32 s11, s11, 5
    s_add_u32 s10, s10, s11
    s_lshl_b32 s11, s49, 4
    s_add_u32 s10, s10, s11
    s_add_u32 s10, s10, 0x310000
    s_cmp_lg_u32 s3, 0
    s_cbranch_scc1 ps_49
    v_mov_b32 v246, s8
    v_mov_b32 v247, s93
    v_lshl_add_u32 v248, v1, 10, s10
    s_mov_b32 exec_lo, 0xffffffff
    s_mov_b32 exec_hi, 0x0
    global_store_dwordx4 v248, v[244:247], s[46:47] sc1
    s_mov_b64 exec, -1
ps_49:
    s_waitcnt lgkmcnt(0)
    ds_read_b128 v[16:19], v57 offset:4096
    ds_read_b128 v[20:23], v57 offset:4160
    s_cmp_lt_u32 s3, 4
    s_cbranch_scc1 b_50
    s_waitcnt vmcnt(0)
b_50:
    s_barrier
    ds_read_b128 v[96:99], v59 offset:0
    ds_read_b128 v[100:103], v60 offset:0
    ds_read_b128 v[104:107], v59 offset:2080
    ds_read_b128 v[108:111], v60 offset:2080
    ds_read_b128 v[112:115], v59 offset:4160
    ds_read_b128 v[116:119], v60 offset:4160
    ds_read_b128 v[120:123], v59 offset:6240
    ds_read_b128 v[124:127], v60 offset:6240
    s_waitcnt lgkmcnt(6)
    v_mfma_f32_16x16x32_bf16 v[24:27], v[96:99], v[16:19], 0
    v_mfma_f32_16x16x32_bf16 v[24:27], v[100:103], v[20:23], v[24:27]
    s_waitcnt lgkmcnt(4)
    v_mfma_f32_16x16x32_bf16 v[28:31], v[104:107], v[16:19], 0
    v_mfma_f32_16x16x32_bf16 v[28:31], v[108:111], v[20:23], v[28:31]
    s_waitcnt lgkmcnt(2)
    v_mfma_f32_16x16x32_bf16 v[32:35], v[112:115], v[16:19], 0
    v_mfma_f32_16x16x32_bf16 v[32:35], v[116:119], v[20:23], v[32:35]
    s_waitcnt lgkmcnt(0)
    v_mfma_f32_16x16x32_bf16 v[36:39], v[120:123], v[16:19], 0
    v_mfma_f32_16x16x32_bf16 v[36:39], v[124:127], v[20:23], v[36:39]
    s_nop 7
    s_mov_b32 exec_lo, 0x10001
    s_mov_b32 exec_hi, 0x10001
    v_cvt_pk_bf16_f32 v64, v24, v25
    v_cvt_pk_bf16_f32 v65, v26, v27
    v_mov_b32 v66, s8
    v_mov_b32 v67, s93
    global_store_dwordx4 v58, v[64:67], s[46:47] offset:0 sc1
    v_cvt_pk_bf16_f32 v68, v28, v29
    v_cvt_pk_bf16_f32 v69, v30, v31
    v_mov_b32 v70, s8
    v_mov_b32 v71, s93
    global_store_dwordx4 v58, v[68:71], s[46:47] offset:64 sc1
    v_cvt_pk_bf16_f32 v72, v32, v33
    v_cvt_pk_bf16_f32 v73, v34, v35
    v_mov_b32 v74, s8
    v_mov_b32 v75, s93
    global_store_dwordx4 v58, v[72:75], s[46:47] offset:128 sc1
    v_cvt_pk_bf16_f32 v76, v36, v37
    v_cvt_pk_bf16_f32 v77, v38, v39
    v_mov_b32 v78, s8
    v_mov_b32 v79, s93
    global_store_dwordx4 v58, v[76:79], s[46:47] offset:192 sc1
    s_mov_b64 exec, -1
    s_branch L_end
L_Bload:
    s_sub_u32 s51, s3, 4
    v_lshrrev_b32 v10, 3, v1
    v_lshlrev_b32 v10, 17, v10
    s_lshl_b32 s10, s51, 20
    s_lshl_b32 s11, s48, 8
    s_add_u32 s10, s10, s11
    s_lshl_b32 s11, s49, 7
    s_add_u32 s10, s10, s11
    v_add_u32 v10, s10, v10
    v_and_b32 v3, 7, v1
    v_lshl_add_u32 v10, v3, 4, v10
    s_add_u32 s12, s20, 0
    s_addc_u32 s13, s21, 0
    global_load_dwordx4 v[64:67], v10, s[12:13] nt
    s_add_u32 s12, s20, 8192
    s_addc_u32 s13, s21, 0
    global_load_dwordx4 v[68:71], v10, s[12:13] nt
    s_add_u32 s12, s20, 16384
    s_addc_u32 s13, s21, 0
    global_load_dwordx4 v[72:75], v10, s[12:13] nt
    s_add_u32 s12, s20, 24576
    s_addc_u32 s13, s21, 0
    global_load_dwordx4 v[76:79], v10, s[12:13] nt
    s_add_u32 s12, s20, 32768
    s_addc_u32 s13, s21, 0
    global_load_dwordx4 v[80:83], v10, s[12:13] nt
    s_add_u32 s12, s20, 40960
    s_addc_u32 s13, s21, 0
    global_load_dwordx4 v[84:87], v10, s[12:13] nt
    s_add_u32 s12, s20, 49152
    s_addc_u32 s13, s21, 0
    global_load_dwordx4 v[88:91], v10, s[12:13] nt
    s_add_u32 s12, s20, 57344
    s_addc_u32 s13, s21, 0
    global_load_dwordx4 v[92:95], v10, s[12:13] nt
    s_add_u32 s12, s20, 65536
    s_addc_u32 s13, s21, 0
    global_load_dwordx4 v[96:99], v10, s[12:13] nt
    s_add_u32 s12, s20, 73728
    s_addc_u32 s13, s21, 0
    global_load_dwordx4 v[100:103], v10, s[12:13] nt
    s_add_u32 s12, s20, 81920
    s_addc_u32 s13, s21, 0
    global_load_dwordx4 v[104:107], v10, s[12:13] nt
    s_add_u32 s12, s20, 90112
    s_addc_u32 s13, s21, 0
    global_load_dwordx4 v[108:111], v10, s[12:13] nt
    s_add_u32 s12, s20, 98304
    s_addc_u32 s13, s21, 0
    global_load_dwordx4 v[112:115], v10, s[12:13] nt
    s_add_u32 s12, s20, 106496
    s_addc_u32 s13, s21, 0
    global_load_dwordx4 v[116:119], v10, s[12:13] nt
    s_add_u32 s12, s20, 114688
    s_addc_u32 s13, s21, 0
    global_load_dwordx4 v[120:123], v10, s[12:13] nt
    s_add_u32 s12, s20, 122880
    s_addc_u32 s13, s21, 0
    global_load_dwordx4 v[124:127], v10, s[12:13] nt
    v_lshrrev_b32 v3, 3, v1
    v_lshlrev_b32 v10, 13, v3
    v_and_b32 v11, 7, v1
    v_xor_b32 v11, v11, v3
    v_lshl_add_u32 v10, v11, 4, v10
    s_lshl_b32 s10, s51, 20
    s_lshl_b32 s11, s48, 8
    s_add_u32 s10, s10, s11
    s_lshl_b32 s11, s49, 7
    s_add_u32 s10, s10, s11
    v_add_u32 v10, s10, v10
    s_mul_i32 s11, s51, 16640
    s_add_u32 s11, s11, 8192
    v_and_b32 v3, 1, v1
    v_lshlrev_b32 v3, 4, v3
    v_mov_b32 v55, 0xffff
    v_lshlrev_b32 v55, v3, v55
    v_bfe_u32 v3, v1, 1, 2
    v_cmp_eq_u32 vcc, 0, v3
    s_nop 1
    v_cndmask_b32 v52, 0, v55, vcc
    v_cmp_eq_u32 vcc, 1, v3
    s_nop 1
    v_cndmask_b32 v53, 0, v55, vcc
    v_cmp_eq_u32 vcc, 2, v3
    s_nop 1
    v_cndmask_b32 v54, 0, v55, vcc
    v_cmp_eq_u32 vcc, 3, v3
    s_nop 1
    v_cndmask_b32 v55, 0, v55, vcc
    s_add_u32 s12, s22, 0
    s_addc_u32 s13, s23, 0
    s_mov_b32 m0, s11
    s_waitcnt vmcnt(15)
    global_load_lds_dwordx4 v10, s[12:13] nt
    s_add_u32 s11, s11, 1040
    s_add_u32 s12, s22, 65536
    s_addc_u32 s13, s23, 0
    s_mov_b32 m0, s11
    s_waitcnt vmcnt(15)
    global_load_lds_dwordx4 v10, s[12:13] nt
    s_add_u32 s11, s11, 1040
    s_add_u32 s12, s22, 131072
    s_addc_u32 s13, s23, 0
    s_mov_b32 m0, s11
    s_waitcnt vmcnt(15)
    global_load_lds_dwordx4 v10, s[12:13] nt
    s_add_u32 s11, s11, 1040
    s_add_u32 s12, s22, 196608
    s_addc_u32 s13, s23, 0
    s_mov_b32 m0, s11
    s_waitcnt vmcnt(15)
    global_load_lds_dwordx4 v10, s[12:13] nt
    s_add_u32 s11, s11, 1040
    s_add_u32 s12, s22, 262144
    s_addc_u32 s13, s23, 0
    s_mov_b32 m0, s11
    s_waitcnt vmcnt(15)
    global_load_lds_dwordx4 v10, s[12:13] nt
    s_add_u32 s11, s11, 1040
    s_add_u32 s12, s22, 327680
    s_addc_u32 s13, s23, 0
    s_mov_b32 m0, s11
    s_waitcnt vmcnt(15)
    global_load_lds_dwordx4 v10, s[12:13] nt
    s_add_u32 s11, s11, 1040
    s_add_u32 s12, s22, 393216
    s_addc_u32 s13, s23, 0
    s_mov_b32 m0, s11
    s_waitcnt vmcnt(15)
    global_load_lds_dwordx4 v10, s[12:13] nt
    s_add_u32 s11, s11, 1040
    s_add_u32 s12, s22, 458752
    s_addc_u32 s13, s23, 0
    s_mov_b32 m0, s11
    s_waitcnt vmcnt(15)
    global_load_lds_dwordx4 v10, s[12:13] nt
    s_add_u32 s11, s11, 1040
    s_add_u32 s12, s22, 524288
    s_addc_u32 s13, s23, 0
    s_mov_b32 m0, s11
    s_waitcnt vmcnt(15)
    global_load_lds_dwordx4 v10, s[12:13] nt
    s_add_u32 s11, s11, 1040
    s_add_u32 s12, s22, 589824
    s_addc_u32 s13, s23, 0
    s_mov_b32 m0, s11
    s_waitcnt vmcnt(15)
    global_load_lds_dwordx4 v10, s[12:13] nt
    s_add_u32 s11, s11, 1040
    s_add_u32 s12, s22, 655360
    s_addc_u32 s13, s23, 0
    s_mov_b32 m0, s11
    s_waitcnt vmcnt(15)
    global_load_lds_dwordx4 v10, s[12:13] nt
    s_add_u32 s11, s11, 1040
    s_add_u32 s12, s22, 720896
    s_addc_u32 s13, s23, 0
    s_mov_b32 m0, s11
    s_waitcnt vmcnt(15)
    global_load_lds_dwordx4 v10, s[12:13] nt
    s_add_u32 s11, s11, 1040
    s_add_u32 s12, s22, 786432
    s_addc_u32 s13, s23, 0
    s_mov_b32 m0, s11
    s_waitcnt vmcnt(15)
    global_load_lds_dwordx4 v10, s[12:13] nt
    s_add_u32 s11, s11, 1040
    s_add_u32 s12, s22, 851968
    s_addc_u32 s13, s23, 0
    s_mov_b32 m0, s11
    s_waitcnt vmcnt(15)
    global_load_lds_dwordx4 v10, s[12:13] nt
    s_add_u32 s11, s11, 1040
    s_add_u32 s12, s22, 917504
    s_addc_u32 s13, s23, 0
    s_mov_b32 m0, s11
    s_waitcnt vmcnt(15)
    global_load_lds_dwordx4 v10, s[12:13] nt
    s_add_u32 s11, s11, 1040
    s_add_u32 s12, s22, 983040
    s_addc_u32 s13, s23, 0
    s_mov_b32 m0, s11
    s_waitcnt vmcnt(15)
    global_load_lds_dwordx4 v10, s[12:13] nt
    s_add_u32 s11, s11, 1040
    v_lshrrev_b32 v2, 3, v1
    v_lshlrev_b32 v2, 6, v2
    s_lshl_b32 s10, s51, 9
    v_add_u32 v2, s10, v2
    v_and_b32 v48, 7, v1
    v_lshlrev_b32 v48, 5, v48
    v_and_b32 v3, 16, v1
    s_lshl_b32 s10, s51, 8
    v_add3_u32 v48, v48, v3, s10
    s_waitcnt vmcnt(16)
    v_readfirstlane_b32 s8, v253
    s_nop 3
    s_add_u32 s8, s8, 1
    s_xor_b32 s93, s8, 0x5bd1e995
    s_barrier
    ds_read_b128 v[136:139], v2 offset:0
    ds_read_b128 v[140:143], v2 offset:16
    ds_read_b128 v[144:147], v2 offset:32
    ds_read_b128 v[148:151], v2 offset:48
    s_waitcnt lgkmcnt(0)
    v_cvt_pk_bf16_f32 v136, v136, v136
    v_cvt_pk_bf16_f32 v137, v137, v137
    v_cvt_pk_bf16_f32 v138, v138, v138
    v_cvt_pk_bf16_f32 v139, v139, v139
    v_cvt_pk_bf16_f32 v140, v140, v140
    v_cvt_pk_bf16_f32 v141, v141, v141
    v_cvt_pk_bf16_f32 v142, v142, v142
    v_cvt_pk_bf16_f32 v143, v143, v143
    v_cvt_pk_bf16_f32 v144, v144, v144
    v_cvt_pk_bf16_f32 v145, v145, v145
    v_cvt_pk_bf16_f32 v146, v146, v146
    v_cvt_pk_bf16_f32 v147, v147, v147
    v_cvt_pk_bf16_f32 v148, v148, v148
    v_cvt_pk_bf16_f32 v149, v149, v149
    v_cvt_pk_bf16_f32 v150, v150, v150
    v_cvt_pk_bf16_f32 v151, v151, v151
    v_and_b32 v24, v136, v52
    v_and_b32 v25, v136, v53
    v_and_b32 v26, v136, v54
    v_and_b32 v27, v136, v55
    v_and_b32 v28, v137, v52
    v_and_b32 v29, v137, v53
    v_and_b32 v30, v137, v54
    v_and_b32 v31, v137, v55
    v_mfma_f32_16x16x32_bf16 v[40:43], v[24:27], v[64:67], 0
    v_and_b32 v32, v138, v52
    v_and_b32 v33, v138, v53
    v_and_b32 v34, v138, v54
    v_and_b32 v35, v138, v55
    v_mfma_f32_16x16x32_bf16 v[40:43], v[28:31], v[68:71], v[40:43]
    v_and_b32 v24, v139, v52
    v_and_b32 v25, v139, v53
    v_and_b32 v26, v139, v54
    v_and_b32 v27, v139, v55
    v_mfma_f32_16x16x32_bf16 v[40:43], v[32:35], v[72:75], v[40:43]
    v_and_b32 v28, v140, v52
    v_and_b32 v29, v140, v53
    v_and_b32 v30, v140, v54
    v_and_b32 v31, v140, v55
    v_mfma_f32_16x16x32_bf16 v[40:43], v[24:27], v[76:79], v[40:43]
    v_and_b32 v32, v141, v52
    v_and_b32 v33, v141, v53
    v_and_b32 v34, v141, v54
    v_and_b32 v35, v141, v55
    v_mfma_f32_16x16x32_bf16 v[40:43], v[28:31], v[80:83], v[40:43]
    v_and_b32 v24, v142, v52
    v_and_b32 v25, v142, v53
    v_and_b32 v26, v142, v54
    v_and_b32 v27, v142, v55
    v_mfma_f32_16x16x32_bf16 v[40:43], v[32:35], v[84:87], v[40:43]
    v_and_b32 v28, v143, v52
    v_and_b32 v29, v143, v53
    v_and_b32 v30, v143, v54
    v_and_b32 v31, v143, v55
    v_mfma_f32_16x16x32_bf16 v[40:43], v[24:27], v[88:91], v[40:43]
    v_and_b32 v32, v144, v52
    v_and_b32 v33, v144, v53
    v_and_b32 v34, v144, v54
    v_and_b32 v35, v144, v55
    v_mfma_f32_16x16x32_bf16 v[40:43], v[28:31], v[92:95], v[40:43]
    v_and_b32 v24, v145, v52
    v_and_b32 v25, v145, v53
    v_and_b32 v26, v145, v54
    v_and_b32 v27, v145, v55
    v_mfma_f32_16x16x32_bf16 v[40:43], v[32:35], v[96:99], v[40:43]
    v_and_b32 v28, v146, v52
    v_and_b32 v29, v146, v53
    v_and_b32 v30, v146, v54
    v_and_b32 v31, v146, v55
    v_mfma_f32_16x16x32_bf16 v[40:43], v[24:27], v[100:103], v[40:43]
    v_and_b32 v32, v147, v52
    v_and_b32 v33, v147, v53
    v_and_b32 v34, v147, v54
    v_and_b32 v35, v147, v55
    v_mfma_f32_16x16x32_bf16 v[40:43], v[28:31], v[104:107], v[40:43]
    v_and_b32 v24, v148, v52
    v_and_b32 v25, v148, v53
    v_and_b32 v26, v148, v54
    v_and_b32 v27, v148, v55
    v_mfma_f32_16x16x32_bf16 v[40:43], v[32:35], v[108:111], v[40:43]
    v_and_b32 v28, v149, v52
    v_and_b32 v29, v149, v53
    v_and_b32 v30, v149, v54
    v_and_b32 v31, v149, v55
    v_mfma_f32_16x16x32_bf16 v[40:43], v[24:27], v[112:115], v[40:43]
    v_and_b32 v32, v150, v52
    v_and_b32 v33, v150, v53
    v_and_b32 v34, v150, v54
    v_and_b32 v35, v150, v55
    v_mfma_f32_16x16x32_bf16 v[40:43], v[28:31], v[116:119], v[40:43]
    v_and_b32 v24, v151, v52
    v_and_b32 v25, v151, v53
    v_and_b32 v26, v151, v54
    v_and_b32 v27, v151, v55
    v_mfma_f32_16x16x32_bf16 v[40:43], v[32:35], v[120:123], v[40:43]
    s_nop 1
    v_mfma_f32_16x16x32_bf16 v[40:43], v[24:27], v[124:127], v[40:43]
    s_nop 7
    v_mov_b32 v44, v40
    v_mov_b32 v45, v41
    v_mov_b32 v46, v42
    v_mov_b32 v47, v43
    s_nop 0
    v_permlane32_swap_b32 v40, v44
    v_permlane32_swap_b32 v41, v45
    v_permlane32_swap_b32 v42, v46
    v_permlane32_swap_b32 v43, v47
    s_nop 0
    v_add_f32_dpp v40, v44, v40 row_ror:8 row_mask:0xf bank_mask:0xf
    v_add_f32_dpp v41, v45, v41 row_ror:8 row_mask:0xf bank_mask:0xf
    v_add_f32_dpp v42, v46, v42 row_ror:8 row_mask:0xf bank_mask:0xf
    v_add_f32_dpp v43, v47, v43 row_ror:8 row_mask:0xf bank_mask:0xf
    s_mov_b32 exec_lo, 0xff00ff
    s_mov_b32 exec_hi, 0x0
    ds_write_b128 v48, v[40:43] offset:2048
    s_mov_b64 exec, -1
    s_waitcnt lgkmcnt(0)
    s_barrier
    s_branch L_B2
L_roleC:
    v_lshrrev_b32 v2, 4, v1
    v_lshlrev_b32 v50, 18, v2
    v_and_b32 v3, 15, v1
    v_lshl_add_u32 v50, v3, 4, v50
    s_lshl_b32 s10, s49, 20
    s_lshl_b32 s11, s48, 11
    s_add_u32 s10, s10, s11
    s_lshl_b32 s11, s3, 8
    s_add_u32 s10, s10, s11
    s_add_u32 s10, s10, 0x100000
    v_add_u32 v50, s10, v50
    s_add_u32 s54, s46, 0
    s_addc_u32 s55, s47, 0
    s_add_u32 s56, s46, 65536
    s_addc_u32 s57, s47, 0
    s_add_u32 s58, s46, 131072
    s_addc_u32 s59, s47, 0
    s_add_u32 s60, s46, 196608
    s_addc_u32 s61, s47, 0
    v_lshlrev_b32 v51, 9, v1
    s_lshl_b32 s10, s49, 13
    s_lshl_b32 s11, s48, 4
    s_add_u32 s10, s10, s11
    s_add_u32 s10, s10, 0x300000
    v_add_u32 v51, s10, v51
    v_and_b32 v2, 127, v0
    v_lshlrev_b32 v52, 4, v2
    s_lshr_b32 s10, s3, 1
    s_lshl_b32 s11, s49, 4
    s_add_u32 s11, s11, s10
    s_lshl_b32 s11, s11, 12
    s_add_u32 s11, s11, 0x10000
    v_add_u32 v52, s11, v52
    s_mul_i32 s10, s10, 1040
    v_lshlrev_b32 v53, 3, v2
    v_add_u32 v53, s10, v53
    v_add_u32 v53, 133120, v53
    s_add_u32 s62, s46, 0
    s_addc_u32 s63, s47, 0
    s_add_u32 s64, s46, 16384
    s_addc_u32 s65, s47, 0
    s_add_u32 s66, s46, 32768
    s_addc_u32 s67, s47, 0
    s_add_u32 s68, s46, 49152
    s_addc_u32 s69, s47, 0
    v_and_b32 v2, 15, v1
    s_movk_i32 s10, 1040
    v_mul_lo_u32 v49, v2, s10
    v_lshrrev_b32 v3, 4, v1
    v_lshl_add_u32 v49, v3, 4, v49
    v_add_u32 v49, 133120, v49
    v_lshlrev_b32 v54, 5, v2
    v_add_u32 v54, 154112, v54
    s_lshl_b32 s10, s3, 2
    v_add_u32 v58, s10, v54
    s_movk_i32 s10, 272
    v_mul_lo_u32 v56, v2, s10
    v_add_u32 v56, 149760, v56
    v_lshl_add_u32 v55, v3, 3, v56
    s_lshl_b32 s10, s3, 5
    v_add_u32 v55, s10, v55
    v_lshl_add_u32 v56, v3, 4, v56
    v_lshlrev_b32 v2, 4, v1
    s_lshl_b32 s10, s48, 17
    s_lshl_b32 s11, s3, 14
    s_add_u32 s10, s10, s11
    s_add_u32 s12, s18, s10
    s_addc_u32 s13, s19, 0
    s_mul_i32 s11, s3, 16640
    s_mov_b32 m0, s11
    s_nop 0
    global_load_lds_dwordx4 v2, s[12:13] nt
    s_add_u32 s12, s12, 1024
    s_addc_u32 s13, s13, 0
    s_add_u32 s11, s11, 1040
    s_mov_b32 m0, s11
    s_nop 0
    global_load_lds_dwordx4 v2, s[12:13] nt
    s_add_u32 s12, s12, 1024
    s_addc_u32 s13, s13, 0
    s_add_u32 s11, s11, 1040
    s_mov_b32 m0, s11
    s_nop 0
    global_load_lds_dwordx4 v2, s[12:13] nt
    s_add_u32 s12, s12, 1024
    s_addc_u32 s13, s13, 0
    s_add_u32 s11, s11, 1040
    s_mov_b32 m0, s11
    s_nop 0
    global_load_lds_dwordx4 v2, s[12:13] nt
    s_add_u32 s12, s12, 1024
    s_addc_u32 s13, s13, 0
    s_add_u32 s11, s11, 1040
    s_mov_b32 m0, s11
    s_nop 0
    global_load_lds_dwordx4 v2, s[12:13] nt
    s_add_u32 s12, s12, 1024
    s_addc_u32 s13, s13, 0
    s_add_u32 s11, s11, 1040
    s_mov_b32 m0, s11
    s_nop 0
    global_load_lds_dwordx4 v2, s[12:13] nt
    s_add_u32 s12, s12, 1024
    s_addc_u32 s13, s13, 0
    s_add_u32 s11, s11, 1040
    s_mov_b32 m0, s11
    s_nop 0
    global_load_lds_dwordx4 v2, s[12:13] nt
    s_add_u32 s12, s12, 1024
    s_addc_u32 s13, s13, 0
    s_add_u32 s11, s11, 1040
    s_mov_b32 m0, s11
    s_nop 0
    global_load_lds_dwordx4 v2, s[12:13] nt
    s_add_u32 s12, s12, 1024
    s_addc_u32 s13, s13, 0
    s_add_u32 s11, s11, 1040
    s_mov_b32 m0, s11
    s_nop 0
    global_load_lds_dwordx4 v2, s[12:13] nt
    s_add_u32 s12, s12, 1024
    s_addc_u32 s13, s13, 0
    s_add_u32 s11, s11, 1040
    s_mov_b32 m0, s11
    s_nop 0
    global_load_lds_dwordx4 v2, s[12:13] nt
    s_add_u32 s12, s12, 1024
    s_addc_u32 s13, s13, 0
    s_add_u32 s11, s11, 1040
    s_mov_b32 m0, s11
    s_nop 0
    global_load_lds_dwordx4 v2, s[12:13] nt
    s_add_u32 s12, s12, 1024
    s_addc_u32 s13, s13, 0
    s_add_u32 s11, s11, 1040
    s_mov_b32 m0, s11
    s_nop 0
    global_load_lds_dwordx4 v2, s[12:13] nt
    s_add_u32 s12, s12, 1024
    s_addc_u32 s13, s13, 0
    s_add_u32 s11, s11, 1040
    s_mov_b32 m0, s11
    s_nop 0
    global_load_lds_dwordx4 v2, s[12:13] nt
    s_add_u32 s12, s12, 1024
    s_addc_u32 s13, s13, 0
    s_add_u32 s11, s11, 1040
    s_mov_b32 m0, s11
    s_nop 0
    global_load_lds_dwordx4 v2, s[12:13] nt
    s_add_u32 s12, s12, 1024
    s_addc_u32 s13, s13, 0
    s_add_u32 s11, s11, 1040
    s_mov_b32 m0, s11
    s_nop 0
    global_load_lds_dwordx4 v2, s[12:13] nt
    s_add_u32 s12, s12, 1024
    s_addc_u32 s13, s13, 0
    s_add_u32 s11, s11, 1040
    s_mov_b32 m0, s11
    s_nop 0
    global_load_lds_dwordx4 v2, s[12:13] nt
    s_waitcnt vmcnt(0)
    v_readfirstlane_b32 s8, v253
    s_nop 3
    s_add_u32 s8, s8, 1
    s_xor_b32 s93, s8, 0x5bd1e995
    s_barrier
    v_and_b32 v2, 15, v1
    s_lshl_b32 s10, s3, 4
    v_add_u32 v2, s10, v2
    s_movk_i32 s10, 1040
    v_mul_lo_u32 v2, v2, s10
    v_lshrrev_b32 v3, 4, v1
    v_lshl_add_u32 v2, v3, 4, v2
    ds_read_b128 v[64:67], v2 offset:0
    ds_read_b128 v[68:71], v2 offset:64
    ds_read_b128 v[72:75], v2 offset:128
    ds_read_b128 v[76:79], v2 offset:192
    ds_read_b128 v[80:83], v2 offset:256
    ds_read_b128 v[84:87], v2 offset:320
    ds_read_b128 v[88:91], v2 offset:384
    ds_read_b128 v[92:95], v2 offset:448
    ds_read_b128 v[96:99], v2 offset:512
    ds_read_b128 v[100:103], v2 offset:576
    ds_read_b128 v[104:107], v2 offset:640
    ds_read_b128 v[108:111], v2 offset:704
    ds_read_b128 v[112:115], v2 offset:768
    ds_read_b128 v[116:119], v2 offset:832
    ds_read_b128 v[120:123], v2 offset:896
    ds_read_b128 v[124:127], v2 offset:960
    v_lshrrev_b32 v2, 4, v1
    v_lshlrev_b32 v2, 3, v2
    v_and_b32 v3, 15, v1
    v_lshrrev_b32 v3, 2, v3
    v_add_u32 v2, v2, v3
    v_mul_lo_u32 v2, v2, s10
    v_and_b32 v3, 3, v1
    v_lshl_add_u32 v2, v3, 3, v2
    s_lshl_b32 s11, s3, 7
    v_add_u32 v2, s11, v2
    v_add_u32 v3, 66560, v2
    ds_read_b64_tr_b16 v[128:129], v2 offset:0
    ds_read_b64_tr_b16 v[130:131], v2 offset:4160
    ds_read_b64_tr_b16 v[132:133], v2 offset:32
    ds_read_b64_tr_b16 v[134:135], v2 offset:4192
    ds_read_b64_tr_b16 v[136:137], v2 offset:64
    ds_read_b64_tr_b16 v[138:139], v2 offset:4224
    ds_read_b64_tr_b16 v[140:141], v2 offset:96
    ds_read_b64_tr_b16 v[142:143], v2 offset:4256
    ds_read_b64_tr_b16 v[144:145], v2 offset:33280
    ds_read_b64_tr_b16 v[146:147], v2 offset:37440
    ds_read_b64_tr_b16 v[148:149], v2 offset:33312
    ds_read_b64_tr_b16 v[150:151], v2 offset:37472
    ds_read_b64_tr_b16 v[152:153], v2 offset:33344
    ds_read_b64_tr_b16 v[154:155], v2 offset:37504
    ds_read_b64_tr_b16 v[156:157], v2 offset:33376
    ds_read_b64_tr_b16 v[158:159], v2 offset:37536
    ds_read_b64_tr_b16 v[160:161], v3 offset:0
    ds_read_b64_tr_b16 v[162:163], v3 offset:4160
    ds_read_b64_tr_b16 v[164:165], v3 offset:32
    ds_read_b64_tr_b16 v[166:167], v3 offset:4192
    ds_read_b64_tr_b16 v[168:169], v3 offset:64
    ds_read_b64_tr_b16 v[170:171], v3 offset:4224
    ds_read_b64_tr_b16 v[172:173], v3 offset:96
    ds_read_b64_tr_b16 v[174:175], v3 offset:4256
    ds_read_b64_tr_b16 v[176:177], v3 offset:33280
    ds_read_b64_tr_b16 v[178:179], v3 offset:37440
    ds_read_b64_tr_b16 v[180:181], v3 offset:33312
    ds_read_b64_tr_b16 v[182:183], v3 offset:37472
    ds_read_b64_tr_b16 v[184:185], v3 offset:33344
    ds_read_b64_tr_b16 v[186:187], v3 offset:37504
    ds_read_b64_tr_b16 v[188:189], v3 offset:33376
    ds_read_b64_tr_b16 v[190:191], v3 offset:37536
    s_waitcnt lgkmcnt(0)
    s_cmp_lg_u32 s3, 0
    s_cbranch_scc1 h_51
    s_lshl_b32 s10, s48, 10
    s_lshl_b32 s11, s49, 9
    s_add_u32 s10, s10, s11
    s_add_u32 s10, s10, 0x310000
    v_lshl_add_u32 v20, v1, 4, s10
    s_mov_b32 exec_lo, 0xffffffff
    s_mov_b32 exec_hi, 0x0
    global_load_dwordx4 v[224:227], v20, s[46:47] sc1
    s_sleep 2
    global_load_dwordx4 v[228:231], v20, s[46:47] sc1
    s_sleep 2
    global_load_dwordx4 v[232:235], v20, s[46:47] sc1
    s_sleep 2
hw_52:
    global_load_dwordx4 v[236:239], v20, s[46:47] sc1
    s_waitcnt vmcnt(3)
    v_xor_b32 v16, s8, v226
    v_xor_b32 v17, s93, v227
    v_or_b32 v16, v16, v17
    v_cmp_ne_u32 vcc, 0, v16
    s_cbranch_vccz hd_53
    s_sleep 1
    global_load_dwordx4 v[224:227], v20, s[46:47] sc1
    s_waitcnt vmcnt(3)
    v_xor_b32 v16, s8, v230
    v_xor_b32 v17, s93, v231
    v_or_b32 v16, v16, v17
    v_cmp_ne_u32 vcc, 0, v16
    s_cbranch_vccz hd_53
    s_sleep 1
    global_load_dwordx4 v[228:231], v20, s[46:47] sc1
    s_waitcnt vmcnt(3)
    v_xor_b32 v16, s8, v234
    v_xor_b32 v17, s93, v235
    v_or_b32 v16, v16, v17
    v_cmp_ne_u32 vcc, 0, v16
    s_cbranch_vccz hd_53
    s_sleep 1
    global_load_dwordx4 v[232:235], v20, s[46:47] sc1
    s_waitcnt vmcnt(3)
    v_xor_b32 v16, s8, v238
    v_xor_b32 v17, s93, v239
    v_or_b32 v16, v16, v17
    v_cmp_ne_u32 vcc, 0, v16
    s_cbranch_vccz hd_53
    s_sleep 1
    s_add_u32 s9, s9, 1
    s_cmp_gt_u32 s9, 400000
    s_cbranch_scc1 L_end
    s_branch hw_52
hd_53:
    s_mov_b64 exec, -1
h_51:
    s_barrier
    s_mov_b32 s53, 0xff
sw_54:
    s_bitcmp1_b32 s53, 0
    s_cbranch_scc0 sk_56
    global_load_dwordx4 v[16:19], v52, s[62:63] sc1
sk_56:
    s_bitcmp1_b32 s53, 1
    s_cbranch_scc0 sk_57
    global_load_dwordx4 v[20:23], v52, s[62:63] offset:2048 sc1
sk_57:
    s_bitcmp1_b32 s53, 2
    s_cbranch_scc0 sk_58
    global_load_dwordx4 v[24:27], v52, s[64:65] sc1
sk_58:
    s_bitcmp1_b32 s53, 3
    s_cbranch_scc0 sk_59
    global_load_dwordx4 v[28:31], v52, s[64:65] offset:2048 sc1
sk_59:
    s_bitcmp1_b32 s53, 4
    s_cbranch_scc0 sk_60
    global_load_dwordx4 v[32:35], v52, s[66:67] sc1
sk_60:
    s_bitcmp1_b32 s53, 5
    s_cbranch_scc0 sk_61
    global_load_dwordx4 v[36:39], v52, s[66:67] offset:2048 sc1
sk_61:
    s_bitcmp1_b32 s53, 6
    s_cbranch_scc0 sk_62
    global_load_dwordx4 v[40:43], v52, s[68:69] sc1
sk_62:
    s_bitcmp1_b32 s53, 7
    s_cbranch_scc0 sk_63
    global_load_dwordx4 v[44:47], v52, s[68:69] offset:2048 sc1
sk_63:
    s_waitcnt vmcnt(0)
    v_xor_b32 v192, s8, v18
    v_xor_b32 v193, s93, v19
    v_or_b32 v192, v192, v193
    v_cmp_ne_u32 vcc, 0, v192
    s_cmp_eq_u64 vcc, 0
    s_cselect_b32 s10, 0xfffffffe, -1
    s_and_b32 s53, s53, s10
    v_xor_b32 v192, s8, v22
    v_xor_b32 v193, s93, v23
    v_or_b32 v192, v192, v193
    v_cmp_ne_u32 vcc, 0, v192
    s_cmp_eq_u64 vcc, 0
    s_cselect_b32 s10, 0xfffffffd, -1
    s_and_b32 s53, s53, s10
    v_xor_b32 v192, s8, v26
    v_xor_b32 v193, s93, v27
    v_or_b32 v192, v192, v193
    v_cmp_ne_u32 vcc, 0, v192
    s_cmp_eq_u64 vcc, 0
    s_cselect_b32 s10, 0xfffffffb, -1
    s_and_b32 s53, s53, s10
    v_xor_b32 v192, s8, v30
    v_xor_b32 v193, s93, v31
    v_or_b32 v192, v192, v193
    v_cmp_ne_u32 vcc, 0, v192
    s_cmp_eq_u64 vcc, 0
    s_cselect_b32 s10, 0xfffffff7, -1
    s_and_b32 s53, s53, s10
    v_xor_b32 v192, s8, v34
    v_xor_b32 v193, s93, v35
    v_or_b32 v192, v192, v193
    v_cmp_ne_u32 vcc, 0, v192
    s_cmp_eq_u64 vcc, 0
    s_cselect_b32 s10, 0xffffffef, -1
    s_and_b32 s53, s53, s10
    v_xor_b32 v192, s8, v38
    v_xor_b32 v193, s93, v39
    v_or_b32 v192, v192, v193
    v_cmp_ne_u32 vcc, 0, v192
    s_cmp_eq_u64 vcc, 0
    s_cselect_b32 s10, 0xffffffdf, -1
    s_and_b32 s53, s53, s10
    v_xor_b32 v192, s8, v42
    v_xor_b32 v193, s93, v43
    v_or_b32 v192, v192, v193
    v_cmp_ne_u32 vcc, 0, v192
    s_cmp_eq_u64 vcc, 0
    s_cselect_b32 s10, 0xffffffbf, -1
    s_and_b32 s53, s53, s10
    v_xor_b32 v192, s8, v46
    v_xor_b32 v193, s93, v47
    v_or_b32 v192, v192, v193
    v_cmp_ne_u32 vcc, 0, v192
    s_cmp_eq_u64 vcc, 0
    s_cselect_b32 s10, 0xffffff7f, -1
    s_and_b32 s53, s53, s10
    s_cmp_eq_u32 s53, 0
    s_cbranch_scc1 sd_55
    s_add_u32 s9, s9, 1
    s_cmp_gt_u32 s9, 400000
    s_cbranch_scc1 L_end
    s_branch sw_54
sd_55:
    v_lshlrev_b32 v2, 16, v16
    v_lshlrev_b32 v3, 16, v20
    v_add_f32 v2, v2, v3
    v_and_b32 v3, 0xffff0000, v16
    v_and_b32 v57, 0xffff0000, v20
    v_add_f32 v3, v3, v57
    v_cvt_pk_bf16_f32 v16, v2, v3
    v_lshlrev_b32 v2, 16, v17
    v_lshlrev_b32 v3, 16, v21
    v_add_f32 v2, v2, v3
    v_and_b32 v3, 0xffff0000, v17
    v_and_b32 v57, 0xffff0000, v21
    v_add_f32 v3, v3, v57
    v_cvt_pk_bf16_f32 v17, v2, v3
    ds_write_b64 v53, v[16:17] offset:0
    v_lshlrev_b32 v2, 16, v24
    v_lshlrev_b32 v3, 16, v28
    v_add_f32 v2, v2, v3
    v_and_b32 v3, 0xffff0000, v24
    v_and_b32 v57, 0xffff0000, v28
    v_add_f32 v3, v3, v57
    v_cvt_pk_bf16_f32 v24, v2, v3
    v_lshlrev_b32 v2, 16, v25
    v_lshlrev_b32 v3, 16, v29
    v_add_f32 v2, v2, v3
    v_and_b32 v3, 0xffff0000, v25
    v_and_b32 v57, 0xffff0000, v29
    v_add_f32 v3, v3, v57
    v_cvt_pk_bf16_f32 v25, v2, v3
    ds_write_b64 v53, v[24:25] offset:4160
    v_lshlrev_b32 v2, 16, v32
    v_lshlrev_b32 v3, 16, v36
    v_add_f32 v2, v2, v3
    v_and_b32 v3, 0xffff0000, v32
    v_and_b32 v57, 0xffff0000, v36
    v_add_f32 v3, v3, v57
    v_cvt_pk_bf16_f32 v32, v2, v3
    v_lshlrev_b32 v2, 16, v33
    v_lshlrev_b32 v3, 16, v37
    v_add_f32 v2, v2, v3
    v_and_b32 v3, 0xffff0000, v33
    v_and_b32 v57, 0xffff0000, v37
    v_add_f32 v3, v3, v57
    v_cvt_pk_bf16_f32 v33, v2, v3
    ds_write_b64 v53, v[32:33] offset:8320
    v_lshlrev_b32 v2, 16, v40
    v_lshlrev_b32 v3, 16, v44
    v_add_f32 v2, v2, v3
    v_and_b32 v3, 0xffff0000, v40
    v_and_b32 v57, 0xffff0000, v44
    v_add_f32 v3, v3, v57
    v_cvt_pk_bf16_f32 v40, v2, v3
    v_lshlrev_b32 v2, 16, v41
    v_lshlrev_b32 v3, 16, v45
    v_add_f32 v2, v2, v3
    v_and_b32 v3, 0xffff0000, v41
    v_and_b32 v57, 0xffff0000, v45
    v_add_f32 v3, v3, v57
    v_cvt_pk_bf16_f32 v41, v2, v3
    ds_write_b64 v53, v[40:41] offset:12480
    s_waitcnt lgkmcnt(0)
    s_barrier
    ds_read_b128 v[192:195], v49 offset:0
    ds_read_b128 v[196:199], v49 offset:64
    ds_read_b128 v[200:203], v49 offset:128
    ds_read_b128 v[204:207], v49 offset:192
    ds_read_b128 v[208:211], v49 offset:256
    ds_read_b128 v[212:215], v49 offset:320
    ds_read_b128 v[216:219], v49 offset:384
    ds_read_b128 v[220:223], v49 offset:448
    ds_read_b128 v[224:227], v49 offset:512
    ds_read_b128 v[228:231], v49 offset:576
    ds_read_b128 v[232:235], v49 offset:640
    ds_read_b128 v[236:239], v49 offset:704
    ds_read_b128 v[240:243], v49 offset:768
    ds_read_b128 v[244:247], v49 offset:832
    ds_read_b128 v[248:251], v49 offset:896
    ds_read_b128 v[252:255], v49 offset:960
    s_waitcnt lgkmcnt(15)
    v_mfma_f32_16x16x32_bf16 v[16:19], v[64:67], v[192:195], 0
    s_waitcnt lgkmcnt(14)
    v_mfma_f32_16x16x32_bf16 v[16:19], v[68:71], v[196:199], v[16:19]
    s_waitcnt lgkmcnt(13)
    v_mfma_f32_16x16x32_bf16 v[16:19], v[72:75], v[200:203], v[16:19]
    s_waitcnt lgkmcnt(12)
    v_mfma_f32_16x16x32_bf16 v[16:19], v[76:79], v[204:207], v[16:19]
    s_waitcnt lgkmcnt(11)
    v_mfma_f32_16x16x32_bf16 v[16:19], v[80:83], v[208:211], v[16:19]
    s_waitcnt lgkmcnt(10)
    v_mfma_f32_16x16x32_bf16 v[16:19], v[84:87], v[212:215], v[16:19]
    s_waitcnt lgkmcnt(9)
    v_mfma_f32_16x16x32_bf16 v[16:19], v[88:91], v[216:219], v[16:19]
    s_waitcnt lgkmcnt(8)
    v_mfma_f32_16x16x32_bf16 v[16:19], v[92:95], v[220:223], v[16:19]
    s_waitcnt lgkmcnt(7)
    v_mfma_f32_16x16x32_bf16 v[16:19], v[96:99], v[224:227], v[16:19]
    s_waitcnt lgkmcnt(6)
    v_mfma_f32_16x16x32_bf16 v[16:19], v[100:103], v[228:231], v[16:19]
    s_waitcnt lgkmcnt(5)
    v_mfma_f32_16x16x32_bf16 v[16:19], v[104:107], v[232:235], v[16:19]
    s_waitcnt lgkmcnt(4)
    v_mfma_f32_16x16x32_bf16 v[16:19], v[108:111], v[236:239], v[16:19]
    s_waitcnt lgkmcnt(3)
    v_mfma_f32_16x16x32_bf16 v[16:19], v[112:115], v[240:243], v[16:19]
    s_waitcnt lgkmcnt(2)
    v_mfma_f32_16x16x32_bf16 v[16:19], v[116:119], v[244:247], v[16:19]
    s_waitcnt lgkmcnt(1)
    v_mfma_f32_16x16x32_bf16 v[16:19], v[120:123], v[248:251], v[16:19]
    s_waitcnt lgkmcnt(0)
    v_mfma_f32_16x16x32_bf16 v[16:19], v[124:127], v[252:255], v[16:19]
    s_nop 7
    v_mul_f32 v16, 0x3e0293ee, v16
    v_mul_f32 v17, 0x3e0293ee, v17
    v_mul_f32 v18, 0x3e0293ee, v18
    v_mul_f32 v19, 0x3e0293ee, v19
    v_max_f32 v20, v16, v17
    v_max3_f32 v20, v20, v18, v19
    v_mov_b32 v21, v20
    s_nop 1
    v_permlane16_swap_b32 v21, v20
    v_max_f32 v20, v20, v21
    v_mov_b32 v21, v20
    s_nop 1
    v_permlane32_swap_b32 v21, v20
    v_max_f32 v20, v20, v21
    s_mov_b32 exec_lo, 0xffff
    s_mov_b32 exec_hi, 0x0
    ds_write_b32 v58, v20
    s_mov_b64 exec, -1
    s_waitcnt lgkmcnt(0)
    s_barrier
    s_lshl_b32 s10, s49, 13
    s_lshl_b32 s11, s48, 4
    s_add_u32 s10, s10, s11
    s_add_u32 s10, s10, 0x308000
    s_cmp_lg_u32 s3, 0
    s_cbranch_scc1 ps_64
    v_mov_b32 v246, s8
    v_mov_b32 v247, s93
    v_lshl_add_u32 v248, v1, 9, s10
    s_mov_b32 exec_lo, 0xffff
    s_mov_b32 exec_hi, 0x0
    global_store_dwordx4 v248, v[244:247], s[46:47] sc1
    s_mov_b64 exec, -1
ps_64:
    ds_read_b128 v[24:27], v54
    ds_read_b128 v[28:31], v54 offset:16
    s_waitcnt lgkmcnt(0)
    v_max3_f32 v20, v24, v25, v26
    v_max3_f32 v20, v20, v27, v28
    v_max3_f32 v20, v20, v29, v30
    v_max_f32 v20, v20, v31
    v_sub_f32 v16, v16, v20
    v_sub_f32 v17, v17, v20
    v_sub_f32 v18, v18, v20
    v_sub_f32 v19, v19, v20
    v_exp_f32 v16, v16
    v_exp_f32 v17, v17
    v_exp_f32 v18, v18
    v_exp_f32 v19, v19
    s_nop 0
    v_cvt_pk_bf16_f32 v22, v16, v17
    v_cvt_pk_bf16_f32 v23, v18, v19
    ds_write_b64 v55, v[22:23]
    v_add_f32 v16, v16, v17
    v_add_f32 v18, v18, v19
    v_add_f32 v16, v16, v18
    v_mov_b32 v21, v16
    s_nop 1
    v_permlane16_swap_b32 v21, v16
    v_add_f32 v16, v16, v21
    v_mov_b32 v21, v16
    s_nop 1
    v_permlane32_swap_b32 v21, v16
    v_add_f32 v16, v16, v21
    s_mov_b32 exec_lo, 0xffff
    s_mov_b32 exec_hi, 0x0
    ds_write_b32 v58, v16 offset:512
    s_mov_b64 exec, -1
    s_waitcnt lgkmcnt(0)
    s_barrier
    ds_read_b128 v[192:195], v56 offset:0
    ds_read_b128 v[196:199], v56 offset:64
    ds_read_b128 v[200:203], v56 offset:128
    ds_read_b128 v[204:207], v56 offset:192
    ds_read_b128 v[40:43], v54 offset:512
    ds_read_b128 v[44:47], v54 offset:528
    s_waitcnt lgkmcnt(5)
    v_mfma_f32_16x16x32_bf16 v[24:27], v[192:195], v[128:131], 0
    v_mfma_f32_16x16x32_bf16 v[28:31], v[192:195], v[132:135], 0
    v_mfma_f32_16x16x32_bf16 v[32:35], v[192:195], v[136:139], 0
    v_mfma_f32_16x16x32_bf16 v[36:39], v[192:195], v[140:143], 0
    s_waitcnt lgkmcnt(4)
    v_mfma_f32_16x16x32_bf16 v[24:27], v[196:199], v[144:147], v[24:27]
    v_mfma_f32_16x16x32_bf16 v[28:31], v[196:199], v[148:151], v[28:31]
    v_mfma_f32_16x16x32_bf16 v[32:35], v[196:199], v[152:155], v[32:35]
    v_mfma_f32_16x16x32_bf16 v[36:39], v[196:199], v[156:159], v[36:39]
    s_waitcnt lgkmcnt(3)
    v_mfma_f32_16x16x32_bf16 v[24:27], v[200:203], v[160:163], v[24:27]
    v_mfma_f32_16x16x32_bf16 v[28:31], v[200:203], v[164:167], v[28:31]
    v_mfma_f32_16x16x32_bf16 v[32:35], v[200:203], v[168:171], v[32:35]
    v_mfma_f32_16x16x32_bf16 v[36:39], v[200:203], v[172:175], v[36:39]
    s_waitcnt lgkmcnt(2)
    v_mfma_f32_16x16x32_bf16 v[24:27], v[204:207], v[176:179], v[24:27]
    v_mfma_f32_16x16x32_bf16 v[28:31], v[204:207], v[180:183], v[28:31]
    v_mfma_f32_16x16x32_bf16 v[32:35], v[204:207], v[184:187], v[32:35]
    v_mfma_f32_16x16x32_bf16 v[36:39], v[204:207], v[188:191], v[36:39]
    v_mov_b32 v22, s8
    v_mov_b32 v23, s93
    s_waitcnt lgkmcnt(0)
    v_add_f32 v40, v40, v41
    v_add_f32 v42, v42, v43
    v_add_f32 v44, v44, v45
    v_add_f32 v46, v46, v47
    v_add_f32 v40, v40, v42
    v_add_f32 v44, v44, v46
    v_add_f32 v21, v40, v44
    s_nop 3
    s_mov_b64 exec, s[96:97]
    v_cvt_pk_bf16_f32 v208, v24, v28
    v_cvt_pk_bf16_f32 v209, v32, v36
    v_mov_b32 v210, s8
    v_mov_b32 v211, s93
    global_store_dwordx4 v50, v[208:211], s[54:55] sc1
    v_cvt_pk_bf16_f32 v212, v25, v29
    v_cvt_pk_bf16_f32 v213, v33, v37
    v_mov_b32 v214, s8
    v_mov_b32 v215, s93
    global_store_dwordx4 v50, v[212:215], s[56:57] sc1
    v_cvt_pk_bf16_f32 v216, v26, v30
    v_cvt_pk_bf16_f32 v217, v34, v38
    v_mov_b32 v218, s8
    v_mov_b32 v219, s93
    global_store_dwordx4 v50, v[216:219], s[58:59] sc1
    v_cvt_pk_bf16_f32 v220, v27, v31
    v_cvt_pk_bf16_f32 v221, v35, v39
    v_mov_b32 v222, s8
    v_mov_b32 v223, s93
    global_store_dwordx4 v50, v[220:223], s[60:61] sc1
    s_cmp_lg_u32 s3, 0
    s_cbranch_scc1 c_65
    s_mov_b32 exec_lo, 0xffff
    s_mov_b32 exec_hi, 0x0
    s_and_b64 exec, exec, s[96:97]
    global_store_dwordx4 v51, v[20:23], s[46:47] sc1
c_65:
    s_mov_b64 exec, -1
    s_branch L_end
L_roleA:
    s_lshl_b32 s51, s48, 16
    s_add_u32 s51, s51, 0x100000
    v_lshrrev_b32 v52, 4, v1
    v_lshlrev_b32 v52, 14, v52
    v_and_b32 v3, 15, v1
    v_lshl_add_u32 v52, v3, 4, v52
    s_lshl_b32 s10, s3, 8
    s_add_u32 s10, s10, s51
    v_add_u32 v52, s10, v52
    s_add_u32 s54, s46, 0
    s_addc_u32 s55, s47, 0
    s_add_u32 s56, s46, 4096
    s_addc_u32 s57, s47, 0
    s_add_u32 s58, s46, 8192
    s_addc_u32 s59, s47, 0
    s_add_u32 s60, s46, 12288
    s_addc_u32 s61, s47, 0
    v_and_b32 v3, 31, v1
    s_lshl_b32 s10, s48, 9
    s_add_u32 s10, s10, 0x300000
    v_lshl_add_u32 v54, v3, 4, s10
    v_lshrrev_b32 v55, 4, v1
    v_lshlrev_b32 v55, 5, v55
    v_lshrrev_b32 v56, 5, v1
    v_lshrrev_b32 v3, 3, v1
    v_and_b32 v3, 2, v3
    v_or_b32 v56, v56, v3
    v_lshlrev_b32 v56, 4, v56
    v_and_b32 v3, 15, v1
    s_lshl_b32 s10, s3, 6
    v_add3_u32 v56, v56, v3, s10
    v_lshlrev_b32 v56, 1, v56
    v_add_u32 v56, 133120, v56
    v_lshrrev_b32 v3, 4, v1
    v_lshlrev_b32 v57, 4, v3
    v_add_u32 v57, 133120, v57
    v_and_b32 v3, 15, v1
    s_lshl_b32 s10, s3, 5
    s_add_u32 s10, s10, 134144
    v_lshl_add_u32 v58, v3, 1, s10
    s_lshl_b32 s10, s48, 11
    s_lshl_b32 s11, s49, 10
    s_add_u32 s10, s10, s11
    s_add_u32 s10, s10, 0x400000
    v_lshl_add_u32 v59, v1, 4, s10
    s_lshl_b32 s10, s3, 6
    s_add_u32 s10, s10, 134400
    v_lshl_add_u32 v60, v3, 2, s10
    v_lshrrev_b32 v61, 4, v1
    v_lshlrev_b32 v61, 7, v61
    v_lshl_add_u32 v61, v3, 2, v61
    v_add_u32 v61, 134400, v61
    s_waitcnt vmcnt(0)
    v_readfirstlane_b32 s8, v253
    s_nop 3
    s_add_u32 s8, s8, 1
    s_xor_b32 s93, s8, 0x5bd1e995
    s_lshl_b32 s10, s48, 7
    s_lshl_b32 s11, s49, 6
    s_add_u32 s10, s10, s11
    s_add_u32 s10, s10, 0x330000
    s_cmp_lg_u32 s3, 0
    s_cbranch_scc1 h_66
    v_mov_b32 v20, s10
    s_mov_b32 exec_lo, 0x1
    s_mov_b32 exec_hi, 0x0
hw_67:
    global_load_dwordx4 v[16:19], v20, s[46:47] sc1
    s_waitcnt vmcnt(0)
    v_xor_b32 v16, s8, v18
    v_xor_b32 v17, s93, v19
    v_or_b32 v16, v16, v17
    v_cmp_ne_u32 vcc, 0, v16
    s_cbranch_vccz hd_68
    s_add_u32 s9, s9, 1
    s_cmp_gt_u32 s9, 400000
    s_cbranch_scc1 L_end
    s_sleep 4
    s_branch hw_67
hd_68:
    s_mov_b64 exec, -1
h_66:
    s_barrier
    v_lshrrev_b32 v2, 4, v1
    v_lshlrev_b32 v2, 13, v2
    v_and_b32 v3, 15, v1
    v_lshl_add_u32 v2, v3, 4, v2
    s_lshl_b32 s10, s3, 19
    s_lshl_b32 s11, s48, 8
    s_add_u32 s10, s10, s11
    v_add_u32 v2, s10, v2
    s_mul_i32 s11, s3, 16640
    s_mov_b32 s12, s24
    s_mov_b32 s13, s25
    s_mov_b32 m0, s11
    s_nop 0
    global_load_lds_dwordx4 v2, s[12:13] nt
    s_add_u32 s12, s12, 32768
    s_addc_u32 s13, s13, 0
    s_add_u32 s11, s11, 1040
    s_mov_b32 m0, s11
    s_nop 0
    global_load_lds_dwordx4 v2, s[12:13] nt
    s_add_u32 s12, s12, 32768
    s_addc_u32 s13, s13, 0
    s_add_u32 s11, s11, 1040
    s_mov_b32 m0, s11
    s_nop 0
    global_load_lds_dwordx4 v2, s[12:13] nt
    s_add_u32 s12, s12, 32768
    s_addc_u32 s13, s13, 0
    s_add_u32 s11, s11, 1040
    s_mov_b32 m0, s11
    s_nop 0
    global_load_lds_dwordx4 v2, s[12:13] nt
    s_add_u32 s12, s12, 32768
    s_addc_u32 s13, s13, 0
    s_add_u32 s11, s11, 1040
    s_mov_b32 m0, s11
    s_nop 0
    global_load_lds_dwordx4 v2, s[12:13] nt
    s_add_u32 s12, s12, 32768
    s_addc_u32 s13, s13, 0
    s_add_u32 s11, s11, 1040
    s_mov_b32 m0, s11
    s_nop 0
    global_load_lds_dwordx4 v2, s[12:13] nt
    s_add_u32 s12, s12, 32768
    s_addc_u32 s13, s13, 0
    s_add_u32 s11, s11, 1040
    s_mov_b32 m0, s11
    s_nop 0
    global_load_lds_dwordx4 v2, s[12:13] nt
    s_add_u32 s12, s12, 32768
    s_addc_u32 s13, s13, 0
    s_add_u32 s11, s11, 1040
    s_mov_b32 m0, s11
    s_nop 0
    global_load_lds_dwordx4 v2, s[12:13] nt
    s_add_u32 s12, s12, 32768
    s_addc_u32 s13, s13, 0
    s_add_u32 s11, s11, 1040
    s_mov_b32 m0, s11
    s_nop 0
    global_load_lds_dwordx4 v2, s[12:13] nt
    s_add_u32 s12, s12, 32768
    s_addc_u32 s13, s13, 0
    s_add_u32 s11, s11, 1040
    s_mov_b32 m0, s11
    s_nop 0
    global_load_lds_dwordx4 v2, s[12:13] nt
    s_add_u32 s12, s12, 32768
    s_addc_u32 s13, s13, 0
    s_add_u32 s11, s11, 1040
    s_mov_b32 m0, s11
    s_nop 0
    global_load_lds_dwordx4 v2, s[12:13] nt
    s_add_u32 s12, s12, 32768
    s_addc_u32 s13, s13, 0
    s_add_u32 s11, s11, 1040
    s_mov_b32 m0, s11
    s_nop 0
    global_load_lds_dwordx4 v2, s[12:13] nt
    s_add_u32 s12, s12, 32768
    s_addc_u32 s13, s13, 0
    s_add_u32 s11, s11, 1040
    s_mov_b32 m0, s11
    s_nop 0
    global_load_lds_dwordx4 v2, s[12:13] nt
    s_add_u32 s12, s12, 32768
    s_addc_u32 s13, s13, 0
    s_add_u32 s11, s11, 1040
    s_mov_b32 m0, s11
    s_nop 0
    global_load_lds_dwordx4 v2, s[12:13] nt
    s_add_u32 s12, s12, 32768
    s_addc_u32 s13, s13, 0
    s_add_u32 s11, s11, 1040
    s_mov_b32 m0, s11
    s_nop 0
    global_load_lds_dwordx4 v2, s[12:13] nt
    s_add_u32 s12, s12, 32768
    s_addc_u32 s13, s13, 0
    s_add_u32 s11, s11, 1040
    s_mov_b32 m0, s11
    s_nop 0
    global_load_lds_dwordx4 v2, s[12:13] nt
    v_lshrrev_b32 v2, 4, v1
    s_movk_i32 s10, 2080
    v_mul_lo_u32 v2, v2, s10
    v_bfe_u32 v3, v1, 2, 2
    v_lshl_add_u32 v2, v3, 8, v2
    v_and_b32 v3, 3, v1
    v_lshl_add_u32 v2, v3, 3, v2
    s_lshl_b32 s10, s3, 5
    v_add_u32 v2, s10, v2
    v_add_u32 v3, 66560, v2
    s_waitcnt vmcnt(0)
    s_barrier
    ds_read_b64_tr_b16 v[64:65], v2 offset:0
    ds_read_b64_tr_b16 v[66:67], v2 offset:1040
    ds_read_b64_tr_b16 v[68:69], v2 offset:8320
    ds_read_b64_tr_b16 v[70:71], v2 offset:9360
    ds_read_b64_tr_b16 v[72:73], v2 offset:16640
    ds_read_b64_tr_b16 v[74:75], v2 offset:17680
    ds_read_b64_tr_b16 v[76:77], v2 offset:24960
    ds_read_b64_tr_b16 v[78:79], v2 offset:26000
    ds_read_b64_tr_b16 v[80:81], v2 offset:33280
    ds_read_b64_tr_b16 v[82:83], v2 offset:34320
    ds_read_b64_tr_b16 v[84:85], v2 offset:41600
    ds_read_b64_tr_b16 v[86:87], v2 offset:42640
    ds_read_b64_tr_b16 v[88:89], v2 offset:49920
    ds_read_b64_tr_b16 v[90:91], v2 offset:50960
    ds_read_b64_tr_b16 v[92:93], v2 offset:58240
    ds_read_b64_tr_b16 v[94:95], v2 offset:59280
    ds_read_b64_tr_b16 v[96:97], v3 offset:0
    ds_read_b64_tr_b16 v[98:99], v3 offset:1040
    ds_read_b64_tr_b16 v[100:101], v3 offset:8320
    ds_read_b64_tr_b16 v[102:103], v3 offset:9360
    ds_read_b64_tr_b16 v[104:105], v3 offset:16640
    ds_read_b64_tr_b16 v[106:107], v3 offset:17680
    ds_read_b64_tr_b16 v[108:109], v3 offset:24960
    ds_read_b64_tr_b16 v[110:111], v3 offset:26000
    ds_read_b64_tr_b16 v[112:113], v3 offset:33280
    ds_read_b64_tr_b16 v[114:115], v3 offset:34320
    ds_read_b64_tr_b16 v[116:117], v3 offset:41600
    ds_read_b64_tr_b16 v[118:119], v3 offset:42640
    ds_read_b64_tr_b16 v[120:121], v3 offset:49920
    ds_read_b64_tr_b16 v[122:123], v3 offset:50960
    ds_read_b64_tr_b16 v[124:125], v3 offset:58240
    ds_read_b64_tr_b16 v[126:127], v3 offset:59280
    s_waitcnt lgkmcnt(0)
    s_barrier
    v_lshrrev_b32 v2, 5, v1
    v_lshlrev_b32 v2, 10, v2
    v_and_b32 v3, 31, v1
    v_lshl_add_u32 v2, v3, 4, v2
    s_lshl_b32 s10, s48, 17
    s_lshl_b32 s11, s3, 14
    s_add_u32 s10, s10, s11
    s_lshl_b32 s11, s49, 9
    s_add_u32 s10, s10, s11
    s_add_u32 s12, s26, s10
    s_addc_u32 s13, s27, 0
    s_mul_i32 s11, s3, 8320
    s_mov_b32 m0, s11
    s_nop 0
    global_load_lds_dwordx4 v2, s[12:13] nt
    s_add_u32 s12, s12, 2048
    s_addc_u32 s13, s13, 0
    s_add_u32 s11, s11, 1040
    s_mov_b32 m0, s11
    s_nop 0
    global_load_lds_dwordx4 v2, s[12:13] nt
    s_add_u32 s12, s12, 2048
    s_addc_u32 s13, s13, 0
    s_add_u32 s11, s11, 1040
    s_mov_b32 m0, s11
    s_nop 0
    global_load_lds_dwordx4 v2, s[12:13] nt
    s_add_u32 s12, s12, 2048
    s_addc_u32 s13, s13, 0
    s_add_u32 s11, s11, 1040
    s_mov_b32 m0, s11
    s_nop 0
    global_load_lds_dwordx4 v2, s[12:13] nt
    s_add_u32 s12, s12, 2048
    s_addc_u32 s13, s13, 0
    s_add_u32 s11, s11, 1040
    s_mov_b32 m0, s11
    s_nop 0
    global_load_lds_dwordx4 v2, s[12:13] nt
    s_add_u32 s12, s12, 2048
    s_addc_u32 s13, s13, 0
    s_add_u32 s11, s11, 1040
    s_mov_b32 m0, s11
    s_nop 0
    global_load_lds_dwordx4 v2, s[12:13] nt
    s_add_u32 s12, s12, 2048
    s_addc_u32 s13, s13, 0
    s_add_u32 s11, s11, 1040
    s_mov_b32 m0, s11
    s_nop 0
    global_load_lds_dwordx4 v2, s[12:13] nt
    s_add_u32 s12, s12, 2048
    s_addc_u32 s13, s13, 0
    s_add_u32 s11, s11, 1040
    s_mov_b32 m0, s11
    s_nop 0
    global_load_lds_dwordx4 v2, s[12:13] nt
    v_lshrrev_b32 v2, 4, v1
    v_lshlrev_b32 v2, 2, v2
    v_bfe_u32 v3, v1, 3, 1
    v_add_u32 v2, v2, v3
    s_movk_i32 s10, 1040
    v_mul_lo_u32 v2, v2, s10
    v_bfe_u32 v3, v1, 2, 1
    v_lshl_add_u32 v2, v3, 9, v2
    v_and_b32 v3, 3, v1
    v_lshl_add_u32 v2, v3, 3, v2
    s_lshl_b32 s11, s3, 6
    v_add_u32 v2, s11, v2
    s_waitcnt vmcnt(0)
    s_barrier
    ds_read_b64_tr_b16 v[128:129], v2 offset:0
    ds_read_b64_tr_b16 v[130:131], v2 offset:2080
    ds_read_b64_tr_b16 v[132:133], v2 offset:32
    ds_read_b64_tr_b16 v[134:135], v2 offset:2112
    ds_read_b64_tr_b16 v[136:137], v2 offset:16640
    ds_read_b64_tr_b16 v[138:139], v2 offset:18720
    ds_read_b64_tr_b16 v[140:141], v2 offset:16672
    ds_read_b64_tr_b16 v[142:143], v2 offset:18752
    ds_read_b64_tr_b16 v[144:145], v2 offset:33280
    ds_read_b64_tr_b16 v[146:147], v2 offset:35360
    ds_read_b64_tr_b16 v[148:149], v2 offset:33312
    ds_read_b64_tr_b16 v[150:151], v2 offset:35392
    ds_read_b64_tr_b16 v[152:153], v2 offset:49920
    ds_read_b64_tr_b16 v[154:155], v2 offset:52000
    ds_read_b64_tr_b16 v[156:157], v2 offset:49952
    ds_read_b64_tr_b16 v[158:159], v2 offset:52032
    s_waitcnt lgkmcnt(0)
    s_cmp_lg_u32 s3, 0
    s_cbranch_scc1 h_69
    s_lshl_b32 s10, s48, 9
    s_add_u32 s10, s10, 0x308000
    v_lshl_add_u32 v20, v1, 4, s10
    s_mov_b32 exec_lo, 0xffffffff
    s_mov_b32 exec_hi, 0x0
    global_load_dwordx4 v[224:227], v20, s[46:47] sc1
    s_sleep 2
    global_load_dwordx4 v[228:231], v20, s[46:47] sc1
    s_sleep 2
    global_load_dwordx4 v[232:235], v20, s[46:47] sc1
    s_sleep 2
hw_70:
    global_load_dwordx4 v[236:239], v20, s[46:47] sc1
    s_waitcnt vmcnt(3)
    v_xor_b32 v16, s8, v226
    v_xor_b32 v17, s93, v227
    v_or_b32 v16, v16, v17
    v_cmp_ne_u32 vcc, 0, v16
    s_cbranch_vccz hd_71
    s_sleep 1
    global_load_dwordx4 v[224:227], v20, s[46:47] sc1
    s_waitcnt vmcnt(3)
    v_xor_b32 v16, s8, v230
    v_xor_b32 v17, s93, v231
    v_or_b32 v16, v16, v17
    v_cmp_ne_u32 vcc, 0, v16
    s_cbranch_vccz hd_71
    s_sleep 1
    global_load_dwordx4 v[228:231], v20, s[46:47] sc1
    s_waitcnt vmcnt(3)
    v_xor_b32 v16, s8, v234
    v_xor_b32 v17, s93, v235
    v_or_b32 v16, v16, v17
    v_cmp_ne_u32 vcc, 0, v16
    s_cbranch_vccz hd_71
    s_sleep 1
    global_load_dwordx4 v[232:235], v20, s[46:47] sc1
    s_waitcnt vmcnt(3)
    v_xor_b32 v16, s8, v238
    v_xor_b32 v17, s93, v239
    v_or_b32 v16, v16, v17
    v_cmp_ne_u32 vcc, 0, v16
    s_cbranch_vccz hd_71
    s_sleep 1
    s_add_u32 s9, s9, 1
    s_cmp_gt_u32 s9, 400000
    s_cbranch_scc1 L_end
    s_branch hw_70
hd_71:
    s_mov_b64 exec, -1
h_69:
    s_barrier
    s_mov_b32 s53, 0x1ff
sw_72:
    s_bitcmp1_b32 s53, 0
    s_cbranch_scc0 sk_74
    global_load_dwordx4 v[16:19], v52, s[54:55] offset:0 sc1
sk_74:
    s_bitcmp1_b32 s53, 1
    s_cbranch_scc0 sk_75
    global_load_dwordx4 v[20:23], v52, s[54:55] offset:2048 sc1
sk_75:
    s_bitcmp1_b32 s53, 2
    s_cbranch_scc0 sk_76
    global_load_dwordx4 v[24:27], v52, s[56:57] offset:0 sc1
sk_76:
    s_bitcmp1_b32 s53, 3
    s_cbranch_scc0 sk_77
    global_load_dwordx4 v[28:31], v52, s[56:57] offset:2048 sc1
sk_77:
    s_bitcmp1_b32 s53, 4
    s_cbranch_scc0 sk_78
    global_load_dwordx4 v[32:35], v52, s[58:59] offset:0 sc1
sk_78:
    s_bitcmp1_b32 s53, 5
    s_cbranch_scc0 sk_79
    global_load_dwordx4 v[36:39], v52, s[58:59] offset:2048 sc1
sk_79:
    s_bitcmp1_b32 s53, 6
    s_cbranch_scc0 sk_80
    global_load_dwordx4 v[40:43], v52, s[60:61] offset:0 sc1
sk_80:
    s_bitcmp1_b32 s53, 7
    s_cbranch_scc0 sk_81
    global_load_dwordx4 v[44:47], v52, s[60:61] offset:2048 sc1
sk_81:
    s_bitcmp1_b32 s53, 8
    s_cbranch_scc0 sk_82
    global_load_dwordx4 v[192:195], v54, s[46:47] sc1
sk_82:
    s_waitcnt vmcnt(0)
    v_xor_b32 v196, s8, v18
    v_xor_b32 v197, s93, v19
    v_or_b32 v196, v196, v197
    v_cmp_ne_u32 vcc, 0, v196
    s_cmp_eq_u64 vcc, 0
    s_cselect_b32 s10, 0xfffffffe, -1
    s_and_b32 s53, s53, s10
    v_xor_b32 v196, s8, v22
    v_xor_b32 v197, s93, v23
    v_or_b32 v196, v196, v197
    v_cmp_ne_u32 vcc, 0, v196
    s_cmp_eq_u64 vcc, 0
    s_cselect_b32 s10, 0xfffffffd, -1
    s_and_b32 s53, s53, s10
    v_xor_b32 v196, s8, v26
    v_xor_b32 v197, s93, v27
    v_or_b32 v196, v196, v197
    v_cmp_ne_u32 vcc, 0, v196
    s_cmp_eq_u64 vcc, 0
    s_cselect_b32 s10, 0xfffffffb, -1
    s_and_b32 s53, s53, s10
    v_xor_b32 v196, s8, v30
    v_xor_b32 v197, s93, v31
    v_or_b32 v196, v196, v197
    v_cmp_ne_u32 vcc, 0, v196
    s_cmp_eq_u64 vcc, 0
    s_cselect_b32 s10, 0xfffffff7, -1
    s_and_b32 s53, s53, s10
    v_xor_b32 v196, s8, v34
    v_xor_b32 v197, s93, v35
    v_or_b32 v196, v196, v197
    v_cmp_ne_u32 vcc, 0, v196
    s_cmp_eq_u64 vcc, 0
    s_cselect_b32 s10, 0xffffffef, -1
    s_and_b32 s53, s53, s10
    v_xor_b32 v196, s8, v38
    v_xor_b32 v197, s93, v39
    v_or_b32 v196, v196, v197
    v_cmp_ne_u32 vcc, 0, v196
    s_cmp_eq_u64 vcc, 0
    s_cselect_b32 s10, 0xffffffdf, -1
    s_and_b32 s53, s53, s10
    v_xor_b32 v196, s8, v42
    v_xor_b32 v197, s93, v43
    v_or_b32 v196, v196, v197
    v_cmp_ne_u32 vcc, 0, v196
    s_cmp_eq_u64 vcc, 0
    s_cselect_b32 s10, 0xffffffbf, -1
    s_and_b32 s53, s53, s10
    v_xor_b32 v196, s8, v46
    v_xor_b32 v197, s93, v47
    v_or_b32 v196, v196, v197
    v_cmp_ne_u32 vcc, 0, v196
    s_cmp_eq_u64 vcc, 0
    s_cselect_b32 s10, 0xffffff7f, -1
    s_and_b32 s53, s53, s10
    v_xor_b32 v196, s8, v194
    v_xor_b32 v197, s93, v195
    v_or_b32 v196, v196, v197
    v_cmp_ne_u32 vcc, 0, v196
    s_cmp_eq_u64 vcc, 0
    s_cselect_b32 s10, 0xfffffeff, -1
    s_and_b32 s53, s53, s10
    s_cmp_eq_u32 s53, 0
    s_cbranch_scc1 sd_73
    s_add_u32 s9, s9, 1
    s_cmp_gt_u32 s9, 400000
    s_cbranch_scc1 L_end
    s_branch sw_72
sd_73:
    v_mov_b32 v196, v192
    s_nop 1
    v_max_f32_dpp v196, v196, v196 row_ror:8 row_mask:0xf bank_mask:0xf
    s_nop 1
    v_max_f32_dpp v196, v196, v196 row_ror:4 row_mask:0xf bank_mask:0xf
    s_nop 1
    v_max_f32_dpp v196, v196, v196 row_ror:2 row_mask:0xf bank_mask:0xf
    s_nop 1
    v_max_f32_dpp v196, v196, v196 row_ror:1 row_mask:0xf bank_mask:0xf
    v_mov_b32 v197, v196
    s_nop 1
    v_permlane16_swap_b32 v197, v196
    v_max_f32 v196, v196, v197
    v_sub_f32 v192, v192, v196
    v_exp_f32 v192, v192
    s_nop 0
    v_mul_f32 v196, v192, v193
    s_nop 1
    v_add_f32_dpp v196, v196, v196 row_ror:8 row_mask:0xf bank_mask:0xf
    s_nop 1
    v_add_f32_dpp v196, v196, v196 row_ror:4 row_mask:0xf bank_mask:0xf
    s_nop 1
    v_add_f32_dpp v196, v196, v196 row_ror:2 row_mask:0xf bank_mask:0xf
    s_nop 1
    v_add_f32_dpp v196, v196, v196 row_ror:1 row_mask:0xf bank_mask:0xf
    v_mov_b32 v197, v196
    s_nop 1
    v_permlane16_swap_b32 v197, v196
    v_add_f32 v196, v196, v197
    v_rcp_f32 v196, v196
    s_nop 0
    v_mul_f32 v192, v192, v196
    ds_bpermute_b32 v200, v55, v192 offset:0
    ds_bpermute_b32 v201, v55, v192 offset:4
    ds_bpermute_b32 v202, v55, v192 offset:8
    ds_bpermute_b32 v203, v55, v192 offset:12
    ds_bpermute_b32 v204, v55, v192 offset:16
    ds_bpermute_b32 v205, v55, v192 offset:20
    ds_bpermute_b32 v206, v55, v192 offset:24
    ds_bpermute_b32 v207, v55, v192 offset:28
    s_waitcnt lgkmcnt(7)
    v_lshlrev_b32 v196, 16, v16
    v_and_b32 v197, 0xffff0000, v16
    v_mul_f32 v208, v200, v196
    v_mul_f32 v209, v200, v197
    v_lshlrev_b32 v196, 16, v17
    v_and_b32 v197, 0xffff0000, v17
    v_mul_f32 v210, v200, v196
    v_mul_f32 v211, v200, v197
    s_waitcnt lgkmcnt(6)
    v_lshlrev_b32 v196, 16, v20
    v_and_b32 v197, 0xffff0000, v20
    v_fmac_f32 v208, v201, v196
    v_fmac_f32 v209, v201, v197
    v_lshlrev_b32 v196, 16, v21
    v_and_b32 v197, 0xffff0000, v21
    v_fmac_f32 v210, v201, v196
    v_fmac_f32 v211, v201, v197
    s_waitcnt lgkmcnt(5)
    v_lshlrev_b32 v196, 16, v24
    v_and_b32 v197, 0xffff0000, v24
    v_fmac_f32 v208, v202, v196
    v_fmac_f32 v209, v202, v197
    v_lshlrev_b32 v196, 16, v25
    v_and_b32 v197, 0xffff0000, v25
    v_fmac_f32 v210, v202, v196
    v_fmac_f32 v211, v202, v197
    s_waitcnt lgkmcnt(4)
    v_lshlrev_b32 v196, 16, v28
    v_and_b32 v197, 0xffff0000, v28
    v_fmac_f32 v208, v203, v196
    v_fmac_f32 v209, v203, v197
    v_lshlrev_b32 v196, 16, v29
    v_and_b32 v197, 0xffff0000, v29
    v_fmac_f32 v210, v203, v196
    v_fmac_f32 v211, v203, v197
    s_waitcnt lgkmcnt(3)
    v_lshlrev_b32 v196, 16, v32
    v_and_b32 v197, 0xffff0000, v32
    v_fmac_f32 v208, v204, v196
    v_fmac_f32 v209, v204, v197
    v_lshlrev_b32 v196, 16, v33
    v_and_b32 v197, 0xffff0000, v33
    v_fmac_f32 v210, v204, v196
    v_fmac_f32 v211, v204, v197
    s_waitcnt lgkmcnt(2)
    v_lshlrev_b32 v196, 16, v36
    v_and_b32 v197, 0xffff0000, v36
    v_fmac_f32 v208, v205, v196
    v_fmac_f32 v209, v205, v197
    v_lshlrev_b32 v196, 16, v37
    v_and_b32 v197, 0xffff0000, v37
    v_fmac_f32 v210, v205, v196
    v_fmac_f32 v211, v205, v197
    s_waitcnt lgkmcnt(1)
    v_lshlrev_b32 v196, 16, v40
    v_and_b32 v197, 0xffff0000, v40
    v_fmac_f32 v208, v206, v196
    v_fmac_f32 v209, v206, v197
    v_lshlrev_b32 v196, 16, v41
    v_and_b32 v197, 0xffff0000, v41
    v_fmac_f32 v210, v206, v196
    v_fmac_f32 v211, v206, v197
    s_waitcnt lgkmcnt(0)
    v_lshlrev_b32 v196, 16, v44
    v_and_b32 v197, 0xffff0000, v44
    v_fmac_f32 v208, v207, v196
    v_fmac_f32 v209, v207, v197
    v_lshlrev_b32 v196, 16, v45
    v_and_b32 v197, 0xffff0000, v45
    v_fmac_f32 v210, v207, v196
    v_fmac_f32 v211, v207, v197
    s_nop 1
    v_permlane32_swap_b32 v208, v209
    v_permlane32_swap_b32 v210, v211
    v_add_f32 v208, v208, v209
    v_add_f32 v210, v210, v211
    s_nop 1
    v_permlane16_swap_b32 v208, v210
    v_add_f32 v208, v208, v210
    v_cvt_pk_bf16_f32 v208, v208, v208
    ds_write_b16 v56, v208
    s_waitcnt lgkmcnt(0)
    s_barrier
    s_lshl_b32 s10, s48, 5
    s_lshl_b32 s11, s49, 4
    s_add_u32 s10, s10, s11
    s_add_u32 s10, s10, 0x320000
    s_cmp_lg_u32 s3, 0
    s_cbranch_scc1 ps_83
    v_mov_b32 v246, s8
    v_mov_b32 v247, s93
    v_lshl_add_u32 v248, v1, 10, s10
    s_mov_b32 exec_lo, 0xffffffff
    s_mov_b32 exec_hi, 0x7ffffff
    global_store_dwordx4 v248, v[244:247], s[46:47] sc1
    s_mov_b64 exec, -1
ps_83:
    ds_read_b128 v[192:195], v57 offset:0
    ds_read_b128 v[196:199], v57 offset:64
    ds_read_b128 v[200:203], v57 offset:128
    ds_read_b128 v[204:207], v57 offset:192
    ds_read_b128 v[208:211], v57 offset:256
    ds_read_b128 v[212:215], v57 offset:320
    ds_read_b128 v[216:219], v57 offset:384
    ds_read_b128 v[220:223], v57 offset:448
    ds_read_b128 v[224:227], v57 offset:512
    ds_read_b128 v[228:231], v57 offset:576
    ds_read_b128 v[232:235], v57 offset:640
    ds_read_b128 v[236:239], v57 offset:704
    ds_read_b128 v[240:243], v57 offset:768
    ds_read_b128 v[244:247], v57 offset:832
    ds_read_b128 v[248:251], v57 offset:896
    ds_read_b128 v[252:255], v57 offset:960
    s_waitcnt lgkmcnt(15)
    v_mfma_f32_16x16x32_bf16 v[16:19], v[192:195], v[64:67], 0
    s_waitcnt lgkmcnt(14)
    v_mfma_f32_16x16x32_bf16 v[16:19], v[196:199], v[68:71], v[16:19]
    s_waitcnt lgkmcnt(13)
    v_mfma_f32_16x16x32_bf16 v[16:19], v[200:203], v[72:75], v[16:19]
    s_waitcnt lgkmcnt(12)
    v_mfma_f32_16x16x32_bf16 v[16:19], v[204:207], v[76:79], v[16:19]
    s_waitcnt lgkmcnt(11)
    v_mfma_f32_16x16x32_bf16 v[16:19], v[208:211], v[80:83], v[16:19]
    s_waitcnt lgkmcnt(10)
    v_mfma_f32_16x16x32_bf16 v[16:19], v[212:215], v[84:87], v[16:19]
    s_waitcnt lgkmcnt(9)
    v_mfma_f32_16x16x32_bf16 v[16:19], v[216:219], v[88:91], v[16:19]
    s_waitcnt lgkmcnt(8)
    v_mfma_f32_16x16x32_bf16 v[16:19], v[220:223], v[92:95], v[16:19]
    s_waitcnt lgkmcnt(7)
    v_mfma_f32_16x16x32_bf16 v[16:19], v[224:227], v[96:99], v[16:19]
    s_waitcnt lgkmcnt(6)
    v_mfma_f32_16x16x32_bf16 v[16:19], v[228:231], v[100:103], v[16:19]
    s_waitcnt lgkmcnt(5)
    v_mfma_f32_16x16x32_bf16 v[16:19], v[232:235], v[104:107], v[16:19]
    s_waitcnt lgkmcnt(4)
    v_mfma_f32_16x16x32_bf16 v[16:19], v[236:239], v[108:111], v[16:19]
    s_waitcnt lgkmcnt(3)
    v_mfma_f32_16x16x32_bf16 v[16:19], v[240:243], v[112:115], v[16:19]
    s_waitcnt lgkmcnt(2)
    v_mfma_f32_16x16x32_bf16 v[16:19], v[244:247], v[116:119], v[16:19]
    s_waitcnt lgkmcnt(1)
    v_mfma_f32_16x16x32_bf16 v[16:19], v[248:251], v[120:123], v[16:19]
    s_waitcnt lgkmcnt(0)
    v_mfma_f32_16x16x32_bf16 v[16:19], v[252:255], v[124:127], v[16:19]
    s_nop 7
    v_cvt_pk_bf16_f32 v16, v16, v16
    s_mov_b32 exec_lo, 0xffff
    s_mov_b32 exec_hi, 0x0
    ds_write_b16 v58, v16
    s_mov_b64 exec, -1
    s_waitcnt lgkmcnt(0)
    s_barrier
    ds_read_b128 v[192:195], v57 offset:1024
    ds_read_b128 v[196:199], v57 offset:1088
    ds_read_b128 v[200:203], v57 offset:1152
    ds_read_b128 v[204:207], v57 offset:1216
    s_waitcnt lgkmcnt(3)
    v_mfma_f32_16x16x32_bf16 v[24:27], v[192:195], v[128:131], 0
    v_mfma_f32_16x16x32_bf16 v[28:31], v[192:195], v[132:135], 0
    s_waitcnt lgkmcnt(2)
    v_mfma_f32_16x16x32_bf16 v[24:27], v[196:199], v[136:139], v[24:27]
    v_mfma_f32_16x16x32_bf16 v[28:31], v[196:199], v[140:143], v[28:31]
    s_waitcnt lgkmcnt(1)
    v_mfma_f32_16x16x32_bf16 v[24:27], v[200:203], v[144:147], v[24:27]
    v_mfma_f32_16x16x32_bf16 v[28:31], v[200:203], v[148:151], v[28:31]
    s_waitcnt lgkmcnt(0)
    v_mfma_f32_16x16x32_bf16 v[24:27], v[204:207], v[152:155], v[24:27]
    v_mfma_f32_16x16x32_bf16 v[28:31], v[204:207], v[156:159], v[28:31]
    s_nop 7
    v_cvt_pk_bf16_f32 v24, v24, v28
    s_mov_b32 exec_lo, 0xffff
    s_mov_b32 exec_hi, 0x0
    ds_write_b32 v60, v24
    s_mov_b64 exec, -1
    s_waitcnt lgkmcnt(0)
    s_barrier
    s_cmp_lg_u32 s3, 0
    s_cbranch_scc1 a_84
    ds_read_b32 v16, v61
    ds_read_b32 v17, v61 offset:64
    v_mov_b32 v18, s8
    v_mov_b32 v19, s93
    s_waitcnt lgkmcnt(0)
    global_store_dwordx4 v59, v[16:19], s[46:47] sc1
a_84:
L_end:
    s_endpgm
.section .rodata,"a"
.p2align 6
.amdhsa_kernel adaLN_cond__compressed_kv_cla__mixer_channel_mlp__decode_kernel
  .amdhsa_next_free_vgpr 256
  .amdhsa_next_free_sgpr 102
  .amdhsa_accum_offset 256
  .amdhsa_group_segment_fixed_size 0
  .amdhsa_kernarg_size 128
  .amdhsa_user_sgpr_count 2
  .amdhsa_user_sgpr_kernarg_segment_ptr 1
  .amdhsa_system_sgpr_workgroup_id_x 1
.end_amdhsa_kernel
```
